```python
import torch

def _softmax(x, axis=-1):
    return torch.softmax(x, dim=axis)

def _gelu(x):
    return torch.nn.functional.gelu(x, approximate='tanh')

def _silu(x):
    return torch.nn.functional.silu(x)

def _sigmoid(x):
    return torch.sigmoid(x)

def _layernorm(x, axis=-1, eps=1e-05):
    m = x.mean(dim=axis, keepdim=True)
    v = x.var(dim=axis, keepdim=True, unbiased=False)
    return (x - m) / torch.sqrt(v + eps)

def _scatter_add(tgt, idx, src, axis=0):
    return tgt.clone().index_add_(axis, idx, src)

def _segment_sum(src, seg, n):
    out = torch.zeros((n,) + src.shape[1:], dtype=src.dtype)
    return out.index_add_(0, seg, src)

def _pad(x, pw):
    flat = tuple((v for pair in reversed(pw) for v in pair))
    return torch.nn.functional.pad(x, flat)
kernel_name = 'gather_scatter__tensor_product_equiv_equiformer__graph'

def setup_inputs():

    _w = lambda a: (lambda t: t.to(torch.bfloat16) if t.is_floating_point() else t)(torch.as_tensor(a))
    N, deg, C, De = (10000, 32, 128, max(0, 1))
    E = N * deg
    src = (lambda lo, hi, *s: torch.randint(lo, hi, s))(0, N, E).to(torch.int64)
    dst = (lambda lo, hi, *s: torch.randint(lo, hi, s))(0, N, E).to(torch.int64)
    rvec = (lambda *s: torch.randn(*s, dtype=torch.bfloat16) * 0.05)(E, 3).to(float)
    rn = (torch.linalg.norm(rvec, dim=-1, keepdim=True) + 1e-06).to(float)
    rhat = (rvec / rn).to(float)
    eps = torch.zeros((3, 3, 3), dtype=float)
    eps[0, 1, 2] = eps[1, 2, 0] = eps[2, 0, 1] = 1.0
    eps[0, 2, 1] = eps[2, 1, 0] = eps[1, 0, 2] = -1.0
    return {'x': _w((lambda *s: torch.randn(*s, dtype=torch.bfloat16) * 0.4)(N, 4 * C).to(float)), 'rhat': _w(rhat), 'e_attr': _w((lambda *s: torch.randn(*s, dtype=torch.bfloat16) * 0.4)(E, De).to(float)), 'src': _w(src), 'dst': _w(dst), 'w_rad': _w((lambda *s: torch.randn(*s, dtype=torch.bfloat16) * 0.4)(De, 5 * C).to(float)), 'w_si0': _w((lambda *s: torch.randn(*s, dtype=torch.bfloat16) * 0.4)(2 * C, C).to(float)), 'w_si1': _w((lambda *s: torch.randn(*s, dtype=torch.bfloat16) * 0.05)(3 * C, C).to(float)), 'cg_eps': _w(eps)}

def reference(x, rhat, e_attr, src, dst, w_rad, w_si0, w_si1, cg_eps):
    N = x.shape[0]
    C = w_si0.shape[1]
    E = rhat.shape[0]
    x0 = x[:, :C].clone()
    x1 = x[:, C:].reshape(N, 3, C)
    R = (e_attr @ w_rad).reshape(E, 5, C)
    f0 = x0[src]
    f1 = x1[src]
    Y1 = rhat
    p00_0 = f0 * R[:, 0, :]
    p11_0 = torch.einsum('ejc,ej->ec', f1, Y1) * R[:, 1, :]
    p01_1 = torch.einsum('ec,ej->ejc', f0, Y1) * R[:, 2, :][:, None, :]
    p10_1 = f1 * R[:, 3, :][:, None, :]
    p11_1 = torch.einsum('ijk,ekc,ej->eic', cg_eps, f1, Y1) * R[:, 4, :][:, None, :]
    m0 = torch.concatenate([p00_0, p11_0], axis=-1) @ w_si0
    m1 = torch.einsum('ejp,pc->ejc', torch.concatenate([p01_1, p10_1, p11_1], axis=-1), w_si1)
    agg0 = _segment_sum(m0, dst, N)
    agg1 = _segment_sum(m1.reshape(E, 3 * C), dst, N).reshape(N, 3, C)
    gate = _sigmoid(agg0)
    out1 = agg1 * gate[:, None, :]
    return torch.concatenate([agg0, out1.reshape(N, 3 * C)], axis=-1)
```

```asm
; @launch kernel=gather_scatter__tensor_product_equiv_equiformer__graph_kernel grid=(256,1,1) block=(768,1,1) lds=157952
.amdgcn_target "amdgcn-amd-amdhsa--gfx950"
.text
.p2align 8
.globl gather_scatter__tensor_product_equiv_equiformer__graph_kernel
.type gather_scatter__tensor_product_equiv_equiformer__graph_kernel,@function
gather_scatter__tensor_product_equiv_equiformer__graph_kernel:
    s_cmp_ge_u32 s2, 256
    s_cbranch_scc1 M_done
    s_load_dwordx16 s[36:51], s[0:1], 0
    s_load_dwordx8 s[52:59], s[0:1], 64
    s_memrealtime s[64:65]
    s_mul_i32 s32, s2, 5000
    v_lshl_add_u32 v6, v0, 3, s32
    v_cmp_gt_u32 vcc, 625, v0
    s_waitcnt lgkmcnt(0)
    s_mov_b64 exec, vcc
    s_cbranch_execz E_nod
    global_load_dwordx2 v[4:5], v6, s[44:45] nt
E_nod:
    s_mov_b64 exec, -1
    v_lshrrev_b32 v1, 6, v0
    v_mov_b32 v3, 0
    v_readfirstlane_b32 s22, v1
    v_lshlrev_b32 v2, 2, v0
    ds_write_b32 v2, v3
    ds_write_b32 v2, v3 offset:2304
    s_mov_b64 s[66:67], s[56:57]
    s_xor_b32 s32, s2, 0
    s_or_b32 s32, s32, s22
    s_cmp_lg_u32 s32, 0
    s_cbranch_scc1 M_nonon
    s_lshl_b32 s65, s65, 22
    s_or_b32 s64, s64, 1
    v_mov_b32 v10, s64
    v_mov_b32 v11, s65
    s_mov_b64 exec, 1
    global_store_dwordx2 v3, v[10:11], s[66:67] sc1
    s_mov_b64 exec, -1
M_nonon:
    s_mov_b32 s3, s2
    v_lshrrev_b32 v20, 1, v6
    v_add_u32 v7, v6, v20
    s_waitcnt lgkmcnt(0)
    s_barrier
    s_cmp_eq_u32 s22, 10
    s_cbranch_scc1 A_scan
    s_cmp_eq_u32 s22, 11
    s_cbranch_scc1 A_aux
    s_mov_b64 exec, vcc
    global_load_dwordx3 v[12:14], v7, s[38:39] nt
    global_load_dword v18, v20, s[40:41] nt
    global_load_dwordx2 v[8:9], v6, s[42:43] nt
    v_mov_b32 v23, 1
    s_mov_b64 s[4:5], s[36:37]
    s_mov_b64 s[8:9], s[54:55]
    s_mov_b64 s[68:69], s[58:59]
    s_and_b32 s32, s2, 7
    s_lshr_b32 s2, s2, 3
    s_lshl_b32 s32, s32, 5
    s_or_b32 s2, s2, s32
    s_mov_b32 s6, 10240000
    s_mov_b32 s7, 0x20000
    s_mov_b32 s10, 10240000
    s_mov_b32 s11, 0x20000
    s_mov_b32 s14, 5242880
    s_mov_b32 s15, 0x20000
    s_mov_b32 s18, 524288
    s_mov_b32 s19, 0x20000
    s_mov_b32 s62, 0xffff0000
    s_mov_b32 s0, 262144
    s_mov_b32 s12, s68
    s_and_b32 s13, s69, 0xffff
    s_add_u32 s16, s68, 5242880
    s_addc_u32 s17, s69, 0
    s_add_u32 s20, s68, 6291456
    s_addc_u32 s21, s69, 0
    s_and_b32 s17, s17, 0xffff
    s_and_b32 s5, s5, 0xffff
    s_and_b32 s9, s9, 0xffff
    s_waitcnt vmcnt(3)
    v_and_b32 v24, 7, v4
    v_bfe_u32 v1, v4, 3, 5
    v_lshlrev_b32 v24, 7, v24
    v_lshl_or_b32 v24, v1, 2, v24
    ds_add_rtn_u32 v28, v24, v23 offset:2304
    v_and_b32 v25, 7, v5
    v_bfe_u32 v1, v5, 3, 5
    v_lshlrev_b32 v25, 7, v25
    v_lshl_or_b32 v25, v1, 2, v25
    ds_add_rtn_u32 v29, v25, v23 offset:2304
    s_waitcnt lgkmcnt(0)
    s_barrier
    v_lshrrev_b32 v4, 8, v4
    v_mul_u32_u24 v1, 43, v4
    v_lshrrev_b32 v1, 9, v1
    v_mul_u32_u24 v2, 12, v1
    v_sub_u32 v4, v4, v2
    v_lshlrev_b32 v1, 14, v1
    v_lshl_or_b32 v34, v4, 16, v1
    v_lshrrev_b32 v5, 8, v5
    v_mul_u32_u24 v1, 43, v5
    v_lshrrev_b32 v1, 9, v1
    v_mul_u32_u24 v2, 12, v1
    v_sub_u32 v5, v5, v2
    v_lshlrev_b32 v1, 14, v1
    v_lshl_or_b32 v38, v5, 16, v1
    s_barrier
    ds_read_b32 v30, v24 offset:6400
    ds_read_b32 v31, v25 offset:6400
    s_waitcnt vmcnt(0)
    v_lshlrev_b32 v4, 16, v18
    v_lshlrev_b32 v5, 16, v12
    v_and_b32 v6, s62, v12
    v_lshlrev_b32 v7, 16, v13
    v_mul_f32 v5, v4, v5
    v_mul_f32 v6, v4, v6
    v_mul_f32 v7, v4, v7
    v_cvt_pk_bf16_f32 v32, v4, v5
    v_cvt_pk_bf16_f32 v33, v6, v7
    v_and_b32 v4, s62, v18
    v_and_b32 v5, s62, v13
    v_lshlrev_b32 v6, 16, v14
    v_and_b32 v7, s62, v14
    v_mul_f32 v5, v4, v5
    v_mul_f32 v6, v4, v6
    v_mul_f32 v7, v4, v7
    v_cvt_pk_bf16_f32 v36, v4, v5
    v_cvt_pk_bf16_f32 v37, v6, v7
    s_waitcnt lgkmcnt(0)
    v_add_lshl_u32 v4, v30, v28, 4
    v_or_b32 v34, v34, v8
    ds_write_b96 v4, v[32:34] offset:10496
    v_add_lshl_u32 v5, v31, v29, 4
    v_or_b32 v38, v38, v9
    ds_write_b96 v5, v[36:38] offset:10496
    s_mov_b64 exec, -1
    s_mul_i32 s32, s3, 20480
    v_lshlrev_b32 v20, 4, v0
    v_add_u32 v21, s32, v20
    v_mov_b32 v2, 2112
    v_add_u32 v22, 10240, v21
    v_cmp_gt_u32 vcc, 616, v0
    s_waitcnt lgkmcnt(0)
    s_barrier
    ds_read_b64 v[2:3], v2
    ds_read_b128 v[32:35], v20 offset:10496
    ds_read_b128 v[36:39], v20 offset:20736
    s_waitcnt lgkmcnt(1)
    v_or_b32 v34, v34, v3
    v_mov_b32 v35, v2
    global_store_dwordx4 v21, v[32:35], s[68:69] sc1
    s_waitcnt lgkmcnt(0)
    v_or_b32 v38, v38, v3
    v_mov_b32 v39, v2
    s_mov_b64 exec, vcc
    global_store_dwordx4 v22, v[36:39], s[68:69] sc1
    v_readfirstlane_b32 s64, v2
    v_readfirstlane_b32 s65, v3
    s_mov_b64 exec, -1
    s_branch A_end
A_scan:
    v_and_b32 v1, 63, v0
    v_lshlrev_b32 v1, 4, v1
    s_lshr_b32 s32, s3, 3
    s_cmp_lg_u32 s32, 0
    s_cbranch_scc1 A_nocpf
    s_getpc_b64 s[60:61]
A_pc:
    s_sub_u32 s60, s60, A_pc-gather_scatter__tensor_product_equiv_equiformer__graph_kernel
    s_subb_u32 s61, s61, 0
    v_lshlrev_b32 v50, 3, v1
    s_mov_b32 s32, M_done-gather_scatter__tensor_product_equiv_equiformer__graph_kernel
    v_add_u32 v51, 8192, v50
    v_min_u32 v51, s32, v51
    v_add_u32 v54, 16384, v50
    v_min_u32 v54, s32, v54
    global_load_dword v52, v50, s[60:61]
    global_load_dword v53, v51, s[60:61]
    global_load_dword v55, v54, s[60:61]
A_nocpf:
    v_mov_b32 v16, 0
    s_setprio 3
    s_barrier
    ds_read_b128 v[4:7], v1 offset:2304
    global_load_dwordx2 v[2:3], v16, s[66:67] sc1
    s_waitcnt lgkmcnt(0)
    v_add_u32 v9, v4, v5
    v_add_u32 v10, v9, v6
    v_add_u32 v11, v10, v7
    v_mov_b32 v12, v11
    s_nop 1
    v_add_u32_dpp v12, v12, v12 row_shr:1 row_mask:0xf bank_mask:0xf bound_ctrl:0
    s_nop 1
    v_add_u32_dpp v12, v12, v12 row_shr:2 row_mask:0xf bank_mask:0xf bound_ctrl:0
    s_nop 1
    v_add_u32_dpp v12, v12, v12 row_shr:4 row_mask:0xf bank_mask:0xf bound_ctrl:0
    s_nop 1
    v_add_u32_dpp v12, v12, v12 row_shr:8 row_mask:0xf bank_mask:0xf bound_ctrl:0
    s_nop 1
    v_add_u32_dpp v12, v12, v12 row_bcast:15 row_mask:0xa bank_mask:0xf
    s_nop 1
    v_add_u32_dpp v12, v12, v12 row_bcast:31 row_mask:0xc bank_mask:0xf
    v_sub_u32 v12, v12, v11
    v_add_u32 v13, v12, v4
    v_add_u32 v14, v12, v9
    v_add_u32 v15, v12, v10
    ds_write_b128 v1, v[12:15] offset:6400
    s_waitcnt lgkmcnt(0)
    s_barrier
    s_mov_b64 s[4:5], s[36:37]
    s_mov_b64 s[8:9], s[54:55]
    s_mov_b64 s[68:69], s[58:59]
    s_and_b32 s32, s2, 7
    s_lshr_b32 s2, s2, 3
    s_lshl_b32 s32, s32, 5
    s_or_b32 s2, s2, s32
    s_mov_b32 s6, 10240000
    s_mov_b32 s7, 0x20000
    s_mov_b32 s10, 10240000
    s_mov_b32 s11, 0x20000
    s_mov_b32 s14, 5242880
    s_mov_b32 s15, 0x20000
    s_mov_b32 s18, 524288
    s_mov_b32 s19, 0x20000
    s_mov_b32 s62, 0xffff0000
    s_mov_b32 s0, 262144
    s_mov_b32 s12, s68
    s_and_b32 s13, s69, 0xffff
    s_add_u32 s16, s68, 5242880
    s_addc_u32 s17, s69, 0
    s_add_u32 s20, s68, 6291456
    s_addc_u32 s21, s69, 0
    s_and_b32 s17, s17, 0xffff
    s_and_b32 s5, s5, 0xffff
    s_and_b32 s9, s9, 0xffff
    s_lshl_b32 s32, s3, 11
    s_add_u32 s32, s32, 5242880
    v_add_u32 v20, s32, v1
    v_lshl_or_b32 v24, v4, 11, v12
    v_lshl_or_b32 v26, v5, 11, v13
    v_lshl_or_b32 v28, v6, 11, v14
    v_lshl_or_b32 v30, v7, 11, v15
    v_mov_b32 v17, 2112
A_pn:
    s_waitcnt vmcnt(0)
    v_readfirstlane_b32 s64, v2
    s_cmp_lg_u32 s64, 0
    s_cbranch_scc1 A_pd
    global_load_dwordx2 v[2:3], v16, s[66:67] sc1
    s_sub_u32 s0, s0, 1
    s_cmp_gt_i32 s0, 0
    s_cbranch_scc1 A_pn
    s_waitcnt vmcnt(0)
A_pd:
    ds_write_b64 v17, v[2:3]
    v_or_b32 v24, v3, v24
    v_mov_b32 v25, v2
    v_or_b32 v26, v3, v26
    v_mov_b32 v27, v2
    v_or_b32 v28, v3, v28
    v_mov_b32 v29, v2
    v_or_b32 v30, v3, v30
    v_mov_b32 v31, v2
    global_store_dwordx4 v20, v[24:27], s[68:69] sc1
    global_store_dwordx4 v20, v[28:31], s[68:69] offset:1024 sc1
    v_readfirstlane_b32 s64, v2
    v_readfirstlane_b32 s65, v3
    v_lshlrev_b32 v40, 7, v1
    s_lshr_b32 s32, s2, 2
    s_lshl_b32 s32, s32, 4
    s_and_b32 s33, s2, 2
    s_lshl_b32 s33, s33, 9
    s_add_u32 s32, s32, s33
    s_and_b32 s33, s2, 1
    s_lshl_b32 s33, s33, 3
    s_add_u32 s32, s32, s33
    v_add_u32 v40, s32, v40
    v_add_u32 v41, 131072, v40
    v_add_u32 v42, 262144, v40
    v_add_u32 v43, 393216, v40
    s_mov_b32 s39, 4290772992
    s_mov_b64 s[40:41], -1
    s_mov_b64 s[42:43], -1
    s_mov_b64 s[44:45], -1
    s_mov_b64 s[46:47], -1
    s_waitcnt lgkmcnt(0)
    s_barrier
    s_waitcnt vmcnt(0)
A_poll:
    s_mov_b64 exec, s[40:41]
    s_cbranch_execz A_ps0
    buffer_load_dwordx2 v[32:33], v40, s[16:19], 0 offen sc1
A_ps0:
    s_mov_b64 exec, s[42:43]
    s_cbranch_execz A_ps1
    buffer_load_dwordx2 v[34:35], v41, s[16:19], 0 offen sc1
A_ps1:
    s_mov_b64 exec, s[44:45]
    s_cbranch_execz A_ps2
    buffer_load_dwordx2 v[36:37], v42, s[16:19], 0 offen sc1
A_ps2:
    s_mov_b64 exec, s[46:47]
    s_cbranch_execz A_ps3
    buffer_load_dwordx2 v[38:39], v43, s[16:19], 0 offen sc1
A_ps3:
    s_mov_b64 exec, -1
    s_mov_b64 s[56:57], 0
    s_waitcnt vmcnt(0)
    v_and_b32 v4, s39, v32
    v_cmp_ne_u32 s[40:41], s65, v4
    v_cmp_ne_u32 vcc, s64, v33
    s_or_b64 s[40:41], s[40:41], vcc
    s_or_b64 s[56:57], s[56:57], s[40:41]
    v_and_b32 v4, s39, v34
    v_cmp_ne_u32 s[42:43], s65, v4
    v_cmp_ne_u32 vcc, s64, v35
    s_or_b64 s[42:43], s[42:43], vcc
    s_or_b64 s[56:57], s[56:57], s[42:43]
    v_and_b32 v4, s39, v36
    v_cmp_ne_u32 s[44:45], s65, v4
    v_cmp_ne_u32 vcc, s64, v37
    s_or_b64 s[44:45], s[44:45], vcc
    s_or_b64 s[56:57], s[56:57], s[44:45]
    v_and_b32 v4, s39, v38
    v_cmp_ne_u32 s[46:47], s65, v4
    v_cmp_ne_u32 vcc, s64, v39
    s_or_b64 s[46:47], s[46:47], vcc
    s_or_b64 s[56:57], s[56:57], s[46:47]
    s_cmp_eq_u64 s[56:57], 0
    s_cbranch_scc1 A_polled
    s_sub_u32 s0, s0, 1
    s_cmp_gt_i32 s0, 0
    s_cbranch_scc1 A_poll
A_polled:
    v_lshrrev_b32 v1, 2, v1
    v_mov_b32 v5, 0
    v_and_b32 v32, 0x3fffff, v32
    ds_write_b32 v1, v32 offset:35072
    v_and_b32 v34, 0x3fffff, v34
    ds_write_b32 v1, v34 offset:35328
    v_and_b32 v36, 0x3fffff, v36
    ds_write_b32 v1, v36 offset:35584
    v_and_b32 v38, 0x3fffff, v38
    ds_write_b32 v1, v38 offset:35840
    ds_write_b32 v1, v5 offset:36096
    s_branch A_end
A_aux:
    v_and_b32 v1, 63, v0
    s_cmp_ge_u32 s3, 160
    s_cbranch_scc1 A_wp1
    s_and_b32 s35, s3, 7
    s_and_b32 s33, s3, 0xf8
    v_lshrrev_b32 v3, 4, v1
    s_lshl_b32 s32, s33, 2
    v_lshl_add_u32 v4, v3, 3, s32
    v_lshlrev_b32 v5, 1, v4
    global_load_dwordx4 v[8:11], v5, s[46:47]
    v_and_b32 v2, 15, v1
    s_lshl_b32 s32, s35, 4
    v_add_lshl_u32 v2, v2, s32, 1
    v_lshl_add_u32 v6, v4, 8, v2
    s_sub_u32 s60, s50, 65536
    s_subb_u32 s61, s51, 0
    s_cmp_lt_u32 s3, 64
    s_cselect_b64 s[60:61], s[48:49], s[60:61]
    global_load_ushort v12, v6, s[60:61] offset:0
    global_load_ushort v13, v6, s[60:61] offset:256
    global_load_ushort v14, v6, s[60:61] offset:512
    global_load_ushort v15, v6, s[60:61] offset:768
    global_load_ushort v16, v6, s[60:61] offset:1024
    global_load_ushort v17, v6, s[60:61] offset:1280
    global_load_ushort v18, v6, s[60:61] offset:1536
    global_load_ushort v19, v6, s[60:61] offset:1792
A_wp1:
    s_setprio 3
    s_barrier
    s_barrier
    s_mov_b64 s[4:5], s[36:37]
    s_mov_b64 s[8:9], s[54:55]
    s_mov_b64 s[68:69], s[58:59]
    s_and_b32 s32, s2, 7
    s_lshr_b32 s2, s2, 3
    s_lshl_b32 s32, s32, 5
    s_or_b32 s2, s2, s32
    s_mov_b32 s6, 10240000
    s_mov_b32 s7, 0x20000
    s_mov_b32 s10, 10240000
    s_mov_b32 s11, 0x20000
    s_mov_b32 s14, 5242880
    s_mov_b32 s15, 0x20000
    s_mov_b32 s18, 524288
    s_mov_b32 s19, 0x20000
    s_mov_b32 s62, 0xffff0000
    s_mov_b32 s0, 262144
    s_mov_b32 s12, s68
    s_and_b32 s13, s69, 0xffff
    s_add_u32 s16, s68, 5242880
    s_addc_u32 s17, s69, 0
    s_add_u32 s20, s68, 6291456
    s_addc_u32 s21, s69, 0
    s_and_b32 s17, s17, 0xffff
    s_and_b32 s5, s5, 0xffff
    s_and_b32 s9, s9, 0xffff
    s_and_b32 s35, s3, 7
    s_mul_i32 s34, s35, 20
    s_lshr_b32 s35, s3, 3
    s_add_u32 s34, s34, s35
    s_cmp_ge_u32 s3, 160
    s_cbranch_scc1 A_nw1
    s_lshl_b32 s35, s34, 10
    s_add_u32 s35, s35, 6291456
    v_lshl_add_u32 v7, v1, 4, s35
    s_waitcnt vmcnt(0)
    v_lshlrev_b32 v20, 16, v8
    v_lshlrev_b32 v12, 16, v12
    v_mul_f32 v12, v20, v12
    v_and_b32 v20, s62, v8
    v_lshlrev_b32 v13, 16, v13
    v_mul_f32 v13, v20, v13
    v_lshlrev_b32 v20, 16, v9
    v_lshlrev_b32 v14, 16, v14
    v_mul_f32 v14, v20, v14
    v_and_b32 v20, s62, v9
    v_lshlrev_b32 v15, 16, v15
    v_mul_f32 v15, v20, v15
    v_lshlrev_b32 v20, 16, v10
    v_lshlrev_b32 v16, 16, v16
    v_mul_f32 v16, v20, v16
    v_and_b32 v20, s62, v10
    v_lshlrev_b32 v17, 16, v17
    v_mul_f32 v17, v20, v17
    v_lshlrev_b32 v20, 16, v11
    v_lshlrev_b32 v18, 16, v18
    v_mul_f32 v18, v20, v18
    v_and_b32 v20, s62, v11
    v_lshlrev_b32 v19, 16, v19
    v_mul_f32 v19, v20, v19
    v_cvt_pk_bf16_f32 v24, v12, v13
    v_cvt_pk_bf16_f32 v25, v14, v15
    v_cvt_pk_bf16_f32 v26, v16, v17
    v_cvt_pk_bf16_f32 v27, v18, v19
    global_store_dwordx4 v7, v[24:27], s[68:69] sc1
A_nw1:
    s_mul_i32 s38, s3, 79
    s_add_u32 s38, s38, 0
    v_and_b32 v32, 63, v0
    v_add_u32 v32, s38, v32
    v_and_b32 v33, 1, v32
    v_lshrrev_b32 v32, 1, v32
    v_lshlrev_b32 v32, 10, v32
    v_lshl_add_u32 v32, v33, 7, v32
    buffer_load_dword v33, v32, s[4:7], 0 offen offset:0
    s_mul_i32 s38, s3, 79
    s_add_u32 s38, s38, 64
    v_and_b32 v34, 63, v0
    v_add_u32 v34, s38, v34
    v_and_b32 v35, 1, v34
    v_lshrrev_b32 v34, 1, v34
    v_lshlrev_b32 v34, 10, v34
    v_lshl_add_u32 v34, v35, 7, v34
    s_mov_b64 exec, 0x7fff
    buffer_load_dword v35, v34, s[4:7], 0 offen offset:0
    s_mov_b64 exec, -1
    v_mov_b32 v2, 2112
    s_barrier
    ds_read_b64 v[4:5], v2
    s_waitcnt lgkmcnt(0)
    v_readfirstlane_b32 s64, v4
    v_readfirstlane_b32 s65, v5
    s_cmp_ge_u32 s3, 160
    s_cbranch_scc1 A_end
    s_lshl_b32 s35, s34, 10
    s_add_u32 s35, s35, 6553600
    v_lshl_add_u32 v11, v1, 4, s35
    v_mov_b32 v5, v4
    v_mov_b32 v6, v4
    v_mov_b32 v7, v4
    s_waitcnt vmcnt(2)
    global_store_dwordx4 v11, v[4:7], s[68:69] sc1
    s_nop 1
A_end:
    s_setprio 0
    s_add_u32 s22, s22, 4
    s_cmp_ge_u32 s22, 12
    s_cselect_b32 s32, 12, 0
    s_sub_u32 s22, s22, s32
    v_mov_b32 v7, 0
    v_mov_b32 v8, 0
    s_mov_b32 s30, 0
    v_and_b32 v12, 63, v0
    v_and_b32 v13, 15, v12
    v_lshrrev_b32 v14, 4, v12
    v_lshlrev_b32 v2, 4, v13
    v_lshlrev_b32 v3, 4, v13
    v_and_b32 v1, 3, v12
    v_bfe_u32 v15, v12, 2, 2
    s_mul_i32 s32, s22, 3584
    s_add_u32 s32, s32, 114944
    v_lshl_add_u32 v4, v14, 4, s32
    v_lshl_add_u32 v5, v15, 6, v4
    s_cmp_lt_u32 s22, 4
    s_cselect_b32 s32, 2, 3
    s_cselect_b32 s33, 0, 12
    s_add_u32 s33, s33, s22
    v_lshlrev_b32 v14, s32, v14
    v_add_u32 v14, s33, v14
    v_cmp_gt_u32 s[58:59], 40, v14
    v_mul_u32_u24 v6, 2816, v14
    v_and_b32 v14, 15, v14
    v_xor_b32 v14, v14, v13
    v_lshl_add_u32 v6, v14, 4, v6
    v_add_u32 v6, 2304, v6
    s_mov_b32 s39, 4290772992
    v_lshrrev_b32 v12, 3, v0
    v_lshlrev_b32 v12, 2, v12
    s_max_u32 s32, s22, 4
    s_sub_u32 s32, s32, 4
    s_mul_i32 s32, s32, 20480
    s_lshl_b32 s33, s2, 2
    s_add_u32 s32, s32, s33
    s_add_u32 s32, s32, 6553600
    v_and_b32 v99, 63, v0
    v_min_u32 v99, 19, v99
    v_lshl_add_u32 v99, v99, 10, s32
    s_waitcnt lgkmcnt(0)
    s_barrier
    ds_read_b32 v9, v12 offset:35072
    ds_read_b32 v10, v12 offset:35456
    ds_read_b32 v11, v12 offset:35840
    s_mov_b64 s[52:53], -1
    s_mov_b32 s63, 0
    s_waitcnt lgkmcnt(0)
    s_branch M_w0
M_init:
    v_mov_b32 v13, 0
    v_lshlrev_b32 v12, 2, v0
    s_movk_i32 s32, 576
    v_cmp_gt_u32 vcc, s32, v0
    s_and_saveexec_b64 s[56:57], vcc
    ds_write_b32 v12, v13
    s_mov_b64 exec, s[56:57]
    s_mov_b64 s[52:53], -1
    s_waitcnt lgkmcnt(0)
    s_barrier
    s_mov_b32 s63, 1
M_w0:
M_window:
    v_and_b32 v12, 7, v0
    v_add_u32 v12, v12, v7
    v_lshrrev_b32 v13, 3, v0
    v_mul_u32_u24 v13, 1280, v13
    v_add_u32 v13, v13, v12
    v_mov_b32 v97, 1
    v_lshrrev_b32 v64, 11, v9
    v_sub_u32 v64, v64, v12
    v_and_b32 v67, 0x7ff, v9
    v_add_lshl_u32 v67, v67, v13, 4
    v_lshrrev_b32 v65, 11, v10
    v_sub_u32 v65, v65, v12
    v_and_b32 v68, 0x7ff, v10
    v_add_lshl_u32 v68, v68, v13, 4
    v_add_u32 v68, 1966080, v68
    v_lshrrev_b32 v66, 11, v11
    v_sub_u32 v66, v66, v12
    v_and_b32 v69, 0x7ff, v11
    v_add_lshl_u32 v69, v69, v13, 4
    v_add_u32 v69, 3932160, v69
    v_cmp_lt_i32 s[40:41], 0, v64
    v_cmp_lt_i32 s[42:43], 0, v65
    v_cmp_lt_i32 s[44:45], 0, v66
    v_cmp_lt_i32 s[46:47], 8, v64
    v_cmp_lt_i32 s[48:49], 8, v65
    v_cmp_lt_i32 s[50:51], 8, v66
    v_cmp_lt_i32 s[24:25], 16, v64
    v_cmp_lt_i32 s[26:27], 16, v65
    v_cmp_lt_i32 s[28:29], 16, v66
    s_cmp_eq_u32 s63, 0
    s_cbranch_scc1 M_rload
    v_and_b32 v14, 1, v8
    v_cmp_eq_u32 vcc, 0, v14
    s_and_b64 s[40:41], s[40:41], vcc
    s_and_b64 s[40:41], s[40:41], s[52:53]
    v_and_b32 v14, 2, v8
    v_cmp_eq_u32 vcc, 0, v14
    s_and_b64 s[42:43], s[42:43], vcc
    s_and_b64 s[42:43], s[42:43], s[52:53]
    v_and_b32 v14, 4, v8
    v_cmp_eq_u32 vcc, 0, v14
    s_and_b64 s[44:45], s[44:45], vcc
    s_and_b64 s[44:45], s[44:45], s[52:53]
    v_and_b32 v14, 8, v8
    v_cmp_eq_u32 vcc, 0, v14
    s_and_b64 s[46:47], s[46:47], vcc
    s_and_b64 s[46:47], s[46:47], s[52:53]
    v_and_b32 v14, 16, v8
    v_cmp_eq_u32 vcc, 0, v14
    s_and_b64 s[48:49], s[48:49], vcc
    s_and_b64 s[48:49], s[48:49], s[52:53]
    v_and_b32 v14, 32, v8
    v_cmp_eq_u32 vcc, 0, v14
    s_and_b64 s[50:51], s[50:51], vcc
    s_and_b64 s[50:51], s[50:51], s[52:53]
    v_and_b32 v14, 64, v8
    v_cmp_eq_u32 vcc, 0, v14
    s_and_b64 s[24:25], s[24:25], vcc
    s_and_b64 s[24:25], s[24:25], s[52:53]
    v_and_b32 v14, 128, v8
    v_cmp_eq_u32 vcc, 0, v14
    s_and_b64 s[26:27], s[26:27], vcc
    s_and_b64 s[26:27], s[26:27], s[52:53]
    v_and_b32 v14, 256, v8
    v_cmp_eq_u32 vcc, 0, v14
    s_and_b64 s[28:29], s[28:29], vcc
    s_and_b64 s[28:29], s[28:29], s[52:53]
M_rload:
    s_or_b64 s[56:57], s[24:25], s[26:27]
    s_or_b64 s[56:57], s[56:57], s[28:29]
    s_cselect_b32 s23, 1, 0
    s_mov_b64 exec, s[40:41]
    buffer_load_dwordx4 v[100:103], v67, s[12:15], 0 offen offset:0 sc1
M_sl0:
    s_mov_b64 exec, s[42:43]
    buffer_load_dwordx4 v[104:107], v68, s[12:15], 0 offen offset:0 sc1
M_sl1:
    s_mov_b64 exec, s[44:45]
    s_cbranch_execz M_sl2
    buffer_load_dwordx4 v[108:111], v69, s[12:15], 0 offen offset:0 sc1
M_sl2:
    s_mov_b64 exec, s[46:47]
    s_cbranch_execz M_sl3
    buffer_load_dwordx4 v[112:115], v67, s[12:15], 0 offen offset:128 sc1
M_sl3:
    s_mov_b64 exec, s[48:49]
    s_cbranch_execz M_sl4
    buffer_load_dwordx4 v[116:119], v68, s[12:15], 0 offen offset:128 sc1
M_sl4:
    s_mov_b64 exec, s[50:51]
    s_cbranch_execz M_sl5
    buffer_load_dwordx4 v[120:123], v69, s[12:15], 0 offen offset:128 sc1
M_sl5:
    s_cmp_eq_u32 s23, 0
    s_cbranch_scc1 M_sl8
    s_mov_b64 exec, s[24:25]
    s_cbranch_execz M_sl6
    buffer_load_dwordx4 v[124:127], v67, s[12:15], 0 offen offset:256 sc1
M_sl6:
    s_mov_b64 exec, s[26:27]
    s_cbranch_execz M_sl7
    buffer_load_dwordx4 v[128:131], v68, s[12:15], 0 offen offset:256 sc1
M_sl7:
    s_mov_b64 exec, s[28:29]
    s_cbranch_execz M_sl8
    buffer_load_dwordx4 v[132:135], v69, s[12:15], 0 offen offset:256 sc1
M_sl8:
    s_mov_b64 exec, -1
    s_cmp_lg_u32 s63, 0
    s_cbranch_scc1 M_nofld
    global_load_dword v98, v99, s[68:69] sc1
M_nofld:
    s_mov_b64 s[54:55], 0
    s_mov_b32 s32, 4290772992
    s_waitcnt vmcnt(0)
    s_mov_b64 exec, s[40:41]
    v_and_b32 v12, s32, v102
    v_cmp_ne_u32 s[56:57], s65, v12
    v_cmp_ne_u32 vcc, s64, v103
    v_bfe_u32 v70, v102, 16, 4
    v_and_b32 v12, 15, v102
    s_or_b64 s[54:55], s[54:55], s[56:57]
    s_or_b64 s[54:55], s[54:55], vcc
    v_lshl_or_b32 v12, v70, 4, v12
    v_lshlrev_b32 v88, 2, v12
M_sc0:
    s_mov_b64 exec, s[42:43]
    v_and_b32 v12, s32, v106
    v_cmp_ne_u32 s[56:57], s65, v12
    v_cmp_ne_u32 vcc, s64, v107
    v_bfe_u32 v71, v106, 16, 4
    v_and_b32 v12, 15, v106
    s_or_b64 s[54:55], s[54:55], s[56:57]
    s_or_b64 s[54:55], s[54:55], vcc
    v_lshl_or_b32 v12, v71, 4, v12
    v_lshlrev_b32 v89, 2, v12
M_sc1:
    s_mov_b64 exec, s[44:45]
    v_and_b32 v12, s32, v110
    v_cmp_ne_u32 s[56:57], s65, v12
    v_cmp_ne_u32 vcc, s64, v111
    v_bfe_u32 v72, v110, 16, 4
    v_and_b32 v12, 15, v110
    s_or_b64 s[54:55], s[54:55], s[56:57]
    s_or_b64 s[54:55], s[54:55], vcc
    v_lshl_or_b32 v12, v72, 4, v12
    v_lshlrev_b32 v90, 2, v12
M_sc2:
    s_mov_b64 exec, s[46:47]
    s_cbranch_execz M_sc3
    v_and_b32 v12, s32, v114
    v_cmp_ne_u32 s[56:57], s65, v12
    v_cmp_ne_u32 vcc, s64, v115
    v_bfe_u32 v73, v114, 16, 4
    v_and_b32 v12, 15, v114
    s_or_b64 s[54:55], s[54:55], s[56:57]
    s_or_b64 s[54:55], s[54:55], vcc
    v_lshl_or_b32 v12, v73, 4, v12
    v_lshlrev_b32 v91, 2, v12
M_sc3:
    s_mov_b64 exec, s[48:49]
    s_cbranch_execz M_sc4
    v_and_b32 v12, s32, v118
    v_cmp_ne_u32 s[56:57], s65, v12
    v_cmp_ne_u32 vcc, s64, v119
    v_bfe_u32 v74, v118, 16, 4
    v_and_b32 v12, 15, v118
    s_or_b64 s[54:55], s[54:55], s[56:57]
    s_or_b64 s[54:55], s[54:55], vcc
    v_lshl_or_b32 v12, v74, 4, v12
    v_lshlrev_b32 v92, 2, v12
M_sc4:
    s_mov_b64 exec, s[50:51]
    s_cbranch_execz M_sc5
    v_and_b32 v12, s32, v122
    v_cmp_ne_u32 s[56:57], s65, v12
    v_cmp_ne_u32 vcc, s64, v123
    v_bfe_u32 v75, v122, 16, 4
    v_and_b32 v12, 15, v122
    s_or_b64 s[54:55], s[54:55], s[56:57]
    s_or_b64 s[54:55], s[54:55], vcc
    v_lshl_or_b32 v12, v75, 4, v12
    v_lshlrev_b32 v93, 2, v12
M_sc5:
    s_cmp_eq_u32 s23, 0
    s_cbranch_scc1 M_sc8
    s_mov_b64 exec, s[24:25]
    s_cbranch_execz M_sc6
    v_and_b32 v12, s32, v126
    v_cmp_ne_u32 s[56:57], s65, v12
    v_cmp_ne_u32 vcc, s64, v127
    v_bfe_u32 v76, v126, 16, 4
    v_and_b32 v12, 15, v126
    s_or_b64 s[54:55], s[54:55], s[56:57]
    s_or_b64 s[54:55], s[54:55], vcc
    v_lshl_or_b32 v12, v76, 4, v12
    v_lshlrev_b32 v94, 2, v12
M_sc6:
    s_mov_b64 exec, s[26:27]
    s_cbranch_execz M_sc7
    v_and_b32 v12, s32, v130
    v_cmp_ne_u32 s[56:57], s65, v12
    v_cmp_ne_u32 vcc, s64, v131
    v_bfe_u32 v77, v130, 16, 4
    v_and_b32 v12, 15, v130
    s_or_b64 s[54:55], s[54:55], s[56:57]
    s_or_b64 s[54:55], s[54:55], vcc
    v_lshl_or_b32 v12, v77, 4, v12
    v_lshlrev_b32 v95, 2, v12
M_sc7:
    s_mov_b64 exec, s[28:29]
    s_cbranch_execz M_sc8
    v_and_b32 v12, s32, v134
    v_cmp_ne_u32 s[56:57], s65, v12
    v_cmp_ne_u32 vcc, s64, v135
    v_bfe_u32 v78, v134, 16, 4
    v_and_b32 v12, 15, v134
    s_or_b64 s[54:55], s[54:55], s[56:57]
    s_or_b64 s[54:55], s[54:55], vcc
    v_lshl_or_b32 v12, v78, 4, v12
    v_lshlrev_b32 v96, 2, v12
M_sc8:
    s_mov_b64 exec, -1
    s_cmp_eq_u64 s[54:55], 0
    s_cbranch_scc1 M_rok
    s_sleep 4
    s_sub_u32 s0, s0, 1
    s_cmp_gt_i32 s0, 0
    s_cbranch_scc1 M_rload
M_rok:
    s_cmp_lg_u32 s63, 0
    s_cbranch_scc1 M_append
    s_mov_b64 exec, s[40:41]
    ds_add_rtn_u32 v79, v88, v97 offset:512
M_sa0:
    s_mov_b64 exec, s[42:43]
    ds_add_rtn_u32 v80, v89, v97 offset:512
M_sa1:
    s_mov_b64 exec, s[44:45]
    ds_add_rtn_u32 v81, v90, v97 offset:512
M_sa2:
    s_mov_b64 exec, s[46:47]
    ds_add_rtn_u32 v82, v91, v97 offset:512
M_sa3:
    s_mov_b64 exec, s[48:49]
    ds_add_rtn_u32 v83, v92, v97 offset:512
M_sa4:
    s_mov_b64 exec, s[50:51]
    ds_add_rtn_u32 v84, v93, v97 offset:512
M_sa5:
    s_cmp_eq_u32 s23, 0
    s_cbranch_scc1 M_sa8
    s_mov_b64 exec, s[24:25]
    ds_add_rtn_u32 v85, v94, v97 offset:512
M_sa6:
    s_mov_b64 exec, s[26:27]
    ds_add_rtn_u32 v86, v95, v97 offset:512
M_sa7:
    s_mov_b64 exec, s[28:29]
    ds_add_rtn_u32 v87, v96, v97 offset:512
M_sa8:
    s_mov_b64 exec, -1
    v_cmp_eq_u32 vcc, s64, v98
    s_cmp_eq_u64 vcc, -1
    s_cselect_b32 s1, 1, 0
    s_cbranch_scc0 M_nowpre
    s_cmp_lt_u32 s22, 4
    s_cbranch_scc1 M_nowpre
    s_sub_u32 s38, s22, 4
    s_mul_i32 s38, s38, 20480
    v_and_b32 v99, 63, v0
    v_lshl_add_u32 v99, v99, 4, s38
    global_load_dwordx4 v[136:139], v99, s[20:21] offset:0 sc1
    global_load_dwordx4 v[140:143], v99, s[20:21] offset:1024 sc1
    global_load_dwordx4 v[144:147], v99, s[20:21] offset:2048 sc1
    global_load_dwordx4 v[148:151], v99, s[20:21] offset:3072 sc1
    v_add_u32 v99, 8192, v99
    global_load_dwordx4 v[152:155], v99, s[20:21] offset:0 sc1
    global_load_dwordx4 v[156:159], v99, s[20:21] offset:1024 sc1
    global_load_dwordx4 v[160:163], v99, s[20:21] offset:2048 sc1
    global_load_dwordx4 v[164:167], v99, s[20:21] offset:3072 sc1
M_nowpre:
    v_and_b32 v12, 63, v0
    v_lshlrev_b32 v12, 4, v12
    v_cmp_lt_u32 vcc, 0, v1
    v_cmp_lt_u32 s[56:57], 1, v1
    s_waitcnt lgkmcnt(0)
    s_barrier
    ds_read_b128 v[48:51], v12 offset:512
    s_cmp_lg_u32 s22, 0
    s_cbranch_scc1 M_t2_0
    s_mul_i32 s38, s3, 79
    s_add_u32 s38, s38, 0
    v_and_b32 v60, 63, v0
    v_add_u32 v60, s38, v60
    v_and_b32 v19, 1, v60
    v_lshrrev_b32 v60, 1, v60
    v_lshlrev_b32 v60, 10, v60
    v_lshl_add_u32 v60, v19, 7, v60
    buffer_load_dword v19, v60, s[4:7], 0 offen offset:256
    s_mul_i32 s38, s3, 79
    s_add_u32 s38, s38, 64
    v_and_b32 v60, 63, v0
    v_add_u32 v60, s38, v60
    v_and_b32 v61, 1, v60
    v_lshrrev_b32 v60, 1, v60
    v_lshlrev_b32 v60, 10, v60
    v_lshl_add_u32 v60, v61, 7, v60
    s_mov_b64 exec, 0x7fff
    buffer_load_dword v61, v60, s[4:7], 0 offen offset:256
    s_mov_b64 exec, -1
M_t2_0:
    s_cmp_lg_u32 s22, 1
    s_cbranch_scc1 M_t2_1
    s_mul_i32 s38, s3, 79
    s_add_u32 s38, s38, 0
    v_and_b32 v60, 63, v0
    v_add_u32 v60, s38, v60
    v_and_b32 v19, 1, v60
    v_lshrrev_b32 v60, 1, v60
    v_lshlrev_b32 v60, 10, v60
    v_lshl_add_u32 v60, v19, 7, v60
    buffer_load_dword v19, v60, s[4:7], 0 offen offset:512
    s_mul_i32 s38, s3, 79
    s_add_u32 s38, s38, 64
    v_and_b32 v60, 63, v0
    v_add_u32 v60, s38, v60
    v_and_b32 v61, 1, v60
    v_lshrrev_b32 v60, 1, v60
    v_lshlrev_b32 v60, 10, v60
    v_lshl_add_u32 v60, v61, 7, v60
    s_mov_b64 exec, 0x7fff
    buffer_load_dword v61, v60, s[4:7], 0 offen offset:512
    s_mov_b64 exec, -1
M_t2_1:
    s_waitcnt lgkmcnt(0)
    v_add_u32 v52, v48, v49
    v_add_u32 v53, v52, v50
    v_add_u32 v54, v53, v51
    s_nop 1
    v_mov_b32_dpp v55, v54 quad_perm:[0,0,1,2] row_mask:0xf bank_mask:0xf
    v_cndmask_b32 v55, 0, v55, vcc
    v_add_u32 v55, v55, v54
    s_nop 1
    v_mov_b32_dpp v56, v55 quad_perm:[0,0,0,1] row_mask:0xf bank_mask:0xf
    v_cndmask_b32 v56, 0, v56, s[56:57]
    v_add_u32 v56, v56, v55
    v_sub_u32 v56, v56, v54
    v_add_u32 v57, v56, v48
    v_add_u32 v58, v56, v52
    v_add_u32 v59, v56, v53
    s_mov_b32 exec_hi, 0xffff
    ds_write_b128 v12, v[56:59] offset:1280
    s_mov_b64 exec, s[40:41]
    ds_read_b32 v88, v88 offset:1280
M_sb0:
    s_mov_b64 exec, s[42:43]
    ds_read_b32 v89, v89 offset:1280
M_sb1:
    s_mov_b64 exec, s[44:45]
    ds_read_b32 v90, v90 offset:1280
M_sb2:
    s_mov_b64 exec, s[46:47]
    ds_read_b32 v91, v91 offset:1280
M_sb3:
    s_mov_b64 exec, s[48:49]
    ds_read_b32 v92, v92 offset:1280
M_sb4:
    s_mov_b64 exec, s[50:51]
    ds_read_b32 v93, v93 offset:1280
M_sb5:
    s_cmp_eq_u32 s23, 0
    s_cbranch_scc1 M_sb8
    s_mov_b64 exec, s[24:25]
    ds_read_b32 v94, v94 offset:1280
M_sb6:
    s_mov_b64 exec, s[26:27]
    ds_read_b32 v95, v95 offset:1280
M_sb7:
    s_mov_b64 exec, s[28:29]
    ds_read_b32 v96, v96 offset:1280
M_sb8:
    s_branch M_place
M_append:
    s_mov_b64 exec, s[40:41]
    v_lshlrev_b32 v13, 2, v70
    v_lshlrev_b32 v12, 6, v70
    ds_add_rtn_u32 v79, v13, v97 offset:2048
    ds_read_b32 v88, v12 offset:1340
    ds_read_b32 v14, v12 offset:572
    s_waitcnt lgkmcnt(0)
    v_add_u32 v88, v88, v14
    s_mov_b64 exec, s[42:43]
    v_lshlrev_b32 v13, 2, v71
    v_lshlrev_b32 v12, 6, v71
    ds_add_rtn_u32 v80, v13, v97 offset:2048
    ds_read_b32 v89, v12 offset:1340
    ds_read_b32 v14, v12 offset:572
    s_waitcnt lgkmcnt(0)
    v_add_u32 v89, v89, v14
    s_mov_b64 exec, s[44:45]
    v_lshlrev_b32 v13, 2, v72
    v_lshlrev_b32 v12, 6, v72
    ds_add_rtn_u32 v81, v13, v97 offset:2048
    ds_read_b32 v90, v12 offset:1340
    ds_read_b32 v14, v12 offset:572
    s_waitcnt lgkmcnt(0)
    v_add_u32 v90, v90, v14
    s_mov_b64 exec, s[46:47]
    v_lshlrev_b32 v13, 2, v73
    v_lshlrev_b32 v12, 6, v73
    ds_add_rtn_u32 v82, v13, v97 offset:2048
    ds_read_b32 v91, v12 offset:1340
    ds_read_b32 v14, v12 offset:572
    s_waitcnt lgkmcnt(0)
    v_add_u32 v91, v91, v14
    s_mov_b64 exec, s[48:49]
    v_lshlrev_b32 v13, 2, v74
    v_lshlrev_b32 v12, 6, v74
    ds_add_rtn_u32 v83, v13, v97 offset:2048
    ds_read_b32 v92, v12 offset:1340
    ds_read_b32 v14, v12 offset:572
    s_waitcnt lgkmcnt(0)
    v_add_u32 v92, v92, v14
    s_mov_b64 exec, s[50:51]
    v_lshlrev_b32 v13, 2, v75
    v_lshlrev_b32 v12, 6, v75
    ds_add_rtn_u32 v84, v13, v97 offset:2048
    ds_read_b32 v93, v12 offset:1340
    ds_read_b32 v14, v12 offset:572
    s_waitcnt lgkmcnt(0)
    v_add_u32 v93, v93, v14
    s_mov_b64 exec, s[24:25]
    v_lshlrev_b32 v13, 2, v76
    v_lshlrev_b32 v12, 6, v76
    ds_add_rtn_u32 v85, v13, v97 offset:2048
    ds_read_b32 v94, v12 offset:1340
    ds_read_b32 v14, v12 offset:572
    s_waitcnt lgkmcnt(0)
    v_add_u32 v94, v94, v14
    s_mov_b64 exec, s[26:27]
    v_lshlrev_b32 v13, 2, v77
    v_lshlrev_b32 v12, 6, v77
    ds_add_rtn_u32 v86, v13, v97 offset:2048
    ds_read_b32 v95, v12 offset:1340
    ds_read_b32 v14, v12 offset:572
    s_waitcnt lgkmcnt(0)
    v_add_u32 v95, v95, v14
    s_mov_b64 exec, s[28:29]
    v_lshlrev_b32 v13, 2, v78
    v_lshlrev_b32 v12, 6, v78
    ds_add_rtn_u32 v87, v13, v97 offset:2048
    ds_read_b32 v96, v12 offset:1340
    ds_read_b32 v14, v12 offset:572
    s_waitcnt lgkmcnt(0)
    v_add_u32 v96, v96, v14
M_place:
    s_mov_b64 exec, -1
    s_mov_b64 s[54:55], 0
    s_mov_b32 s32, 114944
    s_movk_i32 s34, 224
    s_mov_b32 s63, 1
    v_bfe_u32 v13, v102, 14, 2
    v_and_b32 v102, 0x3fff, v102
    v_lshlrev_b32 v103, v13, v97
    v_lshlrev_b32 v102, 10, v102
    v_mul_u32_u24 v70, s34, v70
M_se0:
    v_bfe_u32 v13, v106, 14, 2
    v_and_b32 v106, 0x3fff, v106
    v_lshlrev_b32 v107, v13, v97
    v_lshlrev_b32 v106, 10, v106
    v_mul_u32_u24 v71, s34, v71
M_se1:
    v_bfe_u32 v13, v110, 14, 2
    v_and_b32 v110, 0x3fff, v110
    v_lshlrev_b32 v111, v13, v97
    v_lshlrev_b32 v110, 10, v110
    v_mul_u32_u24 v72, s34, v72
M_se2:
    s_cmp_eq_u64 s[46:47], 0
    s_cbranch_scc1 M_se3
    v_bfe_u32 v13, v114, 14, 2
    v_and_b32 v114, 0x3fff, v114
    v_lshlrev_b32 v115, v13, v97
    v_lshlrev_b32 v114, 10, v114
    v_mul_u32_u24 v73, s34, v73
M_se3:
    s_cmp_eq_u64 s[48:49], 0
    s_cbranch_scc1 M_se4
    v_bfe_u32 v13, v118, 14, 2
    v_and_b32 v118, 0x3fff, v118
    v_lshlrev_b32 v119, v13, v97
    v_lshlrev_b32 v118, 10, v118
    v_mul_u32_u24 v74, s34, v74
M_se4:
    s_cmp_eq_u64 s[50:51], 0
    s_cbranch_scc1 M_se5
    v_bfe_u32 v13, v122, 14, 2
    v_and_b32 v122, 0x3fff, v122
    v_lshlrev_b32 v123, v13, v97
    v_lshlrev_b32 v122, 10, v122
    v_mul_u32_u24 v75, s34, v75
M_se5:
    s_cmp_eq_u32 s23, 0
    s_cbranch_scc1 M_se8
    s_cmp_eq_u64 s[24:25], 0
    s_cbranch_scc1 M_se6
    v_bfe_u32 v13, v126, 14, 2
    v_and_b32 v126, 0x3fff, v126
    v_lshlrev_b32 v127, v13, v97
    v_lshlrev_b32 v126, 10, v126
    v_mul_u32_u24 v76, s34, v76
M_se6:
    s_cmp_eq_u64 s[26:27], 0
    s_cbranch_scc1 M_se7
    v_bfe_u32 v13, v130, 14, 2
    v_and_b32 v130, 0x3fff, v130
    v_lshlrev_b32 v131, v13, v97
    v_lshlrev_b32 v130, 10, v130
    v_mul_u32_u24 v77, s34, v77
M_se7:
    s_cmp_eq_u64 s[28:29], 0
    s_cbranch_scc1 M_se8
    v_bfe_u32 v13, v134, 14, 2
    v_and_b32 v134, 0x3fff, v134
    v_lshlrev_b32 v135, v13, v97
    v_lshlrev_b32 v134, 10, v134
    v_mul_u32_u24 v78, s34, v78
M_se8:
    s_waitcnt lgkmcnt(0)
    s_mov_b64 exec, s[40:41]
    v_add_u32 v79, v79, v88
    v_cmp_gt_u32 vcc, s34, v79
    v_add_u32 v12, v70, v79
    v_lshl_add_u32 v70, v12, 4, s32
    s_andn2_b64 s[56:57], s[40:41], vcc
    s_or_b64 s[54:55], s[54:55], s[56:57]
    s_mov_b64 exec, vcc
    ds_write_b128 v70, v[100:103]
    v_or_b32 v8, 1, v8
M_sp0:
    s_mov_b64 exec, s[42:43]
    v_add_u32 v80, v80, v89
    v_cmp_gt_u32 vcc, s34, v80
    v_add_u32 v12, v71, v80
    v_lshl_add_u32 v71, v12, 4, s32
    s_andn2_b64 s[56:57], s[42:43], vcc
    s_or_b64 s[54:55], s[54:55], s[56:57]
    s_mov_b64 exec, vcc
    ds_write_b128 v71, v[104:107]
    v_or_b32 v8, 2, v8
M_sp1:
    s_mov_b64 exec, s[44:45]
    v_add_u32 v81, v81, v90
    v_cmp_gt_u32 vcc, s34, v81
    v_add_u32 v12, v72, v81
    v_lshl_add_u32 v72, v12, 4, s32
    s_andn2_b64 s[56:57], s[44:45], vcc
    s_or_b64 s[54:55], s[54:55], s[56:57]
    s_mov_b64 exec, vcc
    ds_write_b128 v72, v[108:111]
    v_or_b32 v8, 4, v8
M_sp2:
    s_mov_b64 exec, s[46:47]
    s_cbranch_execz M_sp3
    v_add_u32 v82, v82, v91
    v_cmp_gt_u32 vcc, s34, v82
    v_add_u32 v12, v73, v82
    v_lshl_add_u32 v73, v12, 4, s32
    s_andn2_b64 s[56:57], s[46:47], vcc
    s_or_b64 s[54:55], s[54:55], s[56:57]
    s_mov_b64 exec, vcc
    ds_write_b128 v73, v[112:115]
    v_or_b32 v8, 8, v8
M_sp3:
    s_mov_b64 exec, s[48:49]
    s_cbranch_execz M_sp4
    v_add_u32 v83, v83, v92
    v_cmp_gt_u32 vcc, s34, v83
    v_add_u32 v12, v74, v83
    v_lshl_add_u32 v74, v12, 4, s32
    s_andn2_b64 s[56:57], s[48:49], vcc
    s_or_b64 s[54:55], s[54:55], s[56:57]
    s_mov_b64 exec, vcc
    ds_write_b128 v74, v[116:119]
    v_or_b32 v8, 16, v8
M_sp4:
    s_mov_b64 exec, s[50:51]
    s_cbranch_execz M_sp5
    v_add_u32 v84, v84, v93
    v_cmp_gt_u32 vcc, s34, v84
    v_add_u32 v12, v75, v84
    v_lshl_add_u32 v75, v12, 4, s32
    s_andn2_b64 s[56:57], s[50:51], vcc
    s_or_b64 s[54:55], s[54:55], s[56:57]
    s_mov_b64 exec, vcc
    ds_write_b128 v75, v[120:123]
    v_or_b32 v8, 32, v8
M_sp5:
    s_cmp_eq_u32 s23, 0
    s_cbranch_scc1 M_sp8
    s_mov_b64 exec, s[24:25]
    s_cbranch_execz M_sp6
    v_add_u32 v85, v85, v94
    v_cmp_gt_u32 vcc, s34, v85
    v_add_u32 v12, v76, v85
    v_lshl_add_u32 v76, v12, 4, s32
    s_andn2_b64 s[56:57], s[24:25], vcc
    s_or_b64 s[54:55], s[54:55], s[56:57]
    s_mov_b64 exec, vcc
    ds_write_b128 v76, v[124:127]
    v_or_b32 v8, 64, v8
M_sp6:
    s_mov_b64 exec, s[26:27]
    s_cbranch_execz M_sp7
    v_add_u32 v86, v86, v95
    v_cmp_gt_u32 vcc, s34, v86
    v_add_u32 v12, v77, v86
    v_lshl_add_u32 v77, v12, 4, s32
    s_andn2_b64 s[56:57], s[26:27], vcc
    s_or_b64 s[54:55], s[54:55], s[56:57]
    s_mov_b64 exec, vcc
    ds_write_b128 v77, v[128:131]
    v_or_b32 v8, 128, v8
M_sp7:
    s_mov_b64 exec, s[28:29]
    s_cbranch_execz M_sp8
    v_add_u32 v87, v87, v96
    v_cmp_gt_u32 vcc, s34, v87
    v_add_u32 v12, v78, v87
    v_lshl_add_u32 v78, v12, 4, s32
    s_andn2_b64 s[56:57], s[28:29], vcc
    s_or_b64 s[54:55], s[54:55], s[56:57]
    s_mov_b64 exec, vcc
    ds_write_b128 v78, v[132:135]
    v_or_b32 v8, 256, v8
M_sp8:
    s_mov_b64 exec, -1
    v_mov_b32 v14, 2108
    v_max3_i32 v12, v64, v65, v66
    s_mov_b64 exec, s[54:55]
    ds_write_b32 v14, v97
    s_andn2_b64 s[52:53], s[52:53], s[54:55]
    s_mov_b64 exec, s[52:53]
    v_add_u32 v7, 24, v7
    v_mov_b32 v8, 0
    v_cmp_lt_i32 vcc, 24, v12
    s_mov_b64 exec, -1
    s_cmp_lg_u64 vcc, 0
    s_cbranch_scc1 M_window
    s_lshl_b32 s32, s22, 6
    v_mov_b32 v12, s32
    s_lshl_b32 s32, s22, 2
    v_mov_b32 v13, s32
    s_waitcnt lgkmcnt(0)
    s_barrier
    ds_read_b32 v32, v12 offset:1340
    ds_read_b32 v33, v12 offset:572
    ds_read_b32 v34, v13 offset:2048
    ds_read_b32 v35, v14
    v_and_b32 v12, 63, v0
    v_mov_b32 v40, 16776192
    v_mov_b32 v41, 0
    s_mov_b32 s24, 0
    s_mov_b32 s26, 0
    s_mov_b32 s25, 0
    s_mov_b32 s50, 4194304
    s_mov_b32 s27, 0x05040100
    s_mov_b32 s28, 0x07060302
    s_waitcnt lgkmcnt(0)
    v_add3_u32 v13, v32, v33, v34
    v_readfirstlane_b32 s31, v35
    v_readfirstlane_b32 s32, v13
    s_min_u32 s32, s32, 224
    s_add_u32 s23, s32, 31
    s_lshr_b32 s23, s23, 5
    s_max_u32 s23, s23, 1
    s_lshl_b32 s33, s23, 5
    v_add_u32 v12, s32, v12
    v_cmp_gt_u32 vcc, s33, v12
    s_mul_i32 s34, s22, 3584
    s_add_u32 s34, s34, 114952
    v_lshl_add_u32 v12, v12, 4, s34
    s_mov_b64 exec, vcc
    ds_write_b64 v12, v[40:41]
    s_mov_b64 exec, -1
    s_sub_u32 s29, s32, s33
    s_add_u32 s29, s29, 35
    s_lshr_b32 s29, s29, 2
    s_lshl_b32 s32, s26, 9
    v_add_u32 v12, s32, v4
    v_add_u32 v18, s32, v5
    ds_read2_b32 v[24:25], v12 offset0:2 offset1:18
    ds_read2_b32 v[26:27], v12 offset0:34 offset1:50
    ds_read2_b32 v[28:29], v12 offset0:66 offset1:82
    ds_read2_b32 v[30:31], v12 offset0:98 offset1:114
    ds_read2_b32 v[16:17], v18 offset0:3 offset1:67
    s_cmp_gt_u32 s23, 2
    s_cbranch_scc1 M_nozl
    v_mov_b32 v104, 0
    v_mov_b32 v105, 0
    v_mov_b32 v106, 0
    v_mov_b32 v107, 0
    v_mov_b32 v108, 0
    v_mov_b32 v109, 0
    v_mov_b32 v110, 0
    v_mov_b32 v111, 0
    v_mov_b32 v112, 0
    v_mov_b32 v113, 0
    v_mov_b32 v114, 0
    v_mov_b32 v115, 0
    v_mov_b32 v116, 0
    v_mov_b32 v117, 0
    v_mov_b32 v118, 0
    v_mov_b32 v119, 0
    v_mov_b32 v120, 0
    v_mov_b32 v121, 0
    v_mov_b32 v122, 0
    v_mov_b32 v123, 0
    v_mov_b32 v124, 0
    v_mov_b32 v125, 0
    v_mov_b32 v126, 0
    v_mov_b32 v127, 0
    v_mov_b32 v128, 0
    v_mov_b32 v129, 0
    v_mov_b32 v130, 0
    v_mov_b32 v131, 0
    v_mov_b32 v132, 0
    v_mov_b32 v133, 0
    v_mov_b32 v134, 0
    v_mov_b32 v135, 0
    s_cmp_ge_u32 s22, 4
    s_cbranch_scc1 M_nozl
    v_mov_b32 v136, 0
    v_mov_b32 v137, 0
    v_mov_b32 v138, 0
    v_mov_b32 v139, 0
    v_mov_b32 v140, 0
    v_mov_b32 v141, 0
    v_mov_b32 v142, 0
    v_mov_b32 v143, 0
    v_mov_b32 v144, 0
    v_mov_b32 v145, 0
    v_mov_b32 v146, 0
    v_mov_b32 v147, 0
    v_mov_b32 v148, 0
    v_mov_b32 v149, 0
    v_mov_b32 v150, 0
    v_mov_b32 v151, 0
    v_mov_b32 v152, 0
    v_mov_b32 v153, 0
    v_mov_b32 v154, 0
    v_mov_b32 v155, 0
    v_mov_b32 v156, 0
    v_mov_b32 v157, 0
    v_mov_b32 v158, 0
    v_mov_b32 v159, 0
    v_mov_b32 v160, 0
    v_mov_b32 v161, 0
    v_mov_b32 v162, 0
    v_mov_b32 v163, 0
    v_mov_b32 v164, 0
    v_mov_b32 v165, 0
    v_mov_b32 v166, 0
    v_mov_b32 v167, 0
M_nozl:
    s_setprio 3
    s_waitcnt lgkmcnt(0)
    s_cmp_ge_u32 s22, 4
    s_cbranch_scc1 M_sglb
    v_pk_add_f32 v[24:25], v[24:25], v[2:3]
    v_pk_add_f32 v[26:27], v[26:27], v[2:3]
    v_pk_add_f32 v[28:29], v[28:29], v[2:3]
    v_pk_add_f32 v[30:31], v[30:31], v[2:3]
    v_bfe_i32 v16, v16, v1, 1
    v_bfe_i32 v17, v17, v1, 1
    s_add_u32 s26, s24, 1
    v_and_b32 v16, v16, v18
    v_and_b32 v17, v17, v18
    s_cmp_eq_u32 s26, s23
    ds_read_b64_tr_b16 v[32:33], v16
    ds_read_b64_tr_b16 v[34:35], v17 offset:256
    s_cbranch_scc1 M_parti
M_fulli:
    buffer_load_dwordx4 v[104:107], v24, s[4:7], s25 offen
    buffer_load_dwordx4 v[108:111], v25, s[4:7], s25 offen
    buffer_load_dwordx4 v[112:115], v26, s[4:7], s25 offen
    buffer_load_dwordx4 v[116:119], v27, s[4:7], s25 offen
    buffer_load_dwordx4 v[120:123], v28, s[4:7], s25 offen
    buffer_load_dwordx4 v[124:127], v29, s[4:7], s25 offen
    buffer_load_dwordx4 v[128:131], v30, s[4:7], s25 offen
    buffer_load_dwordx4 v[132:135], v31, s[4:7], s25 offen
    s_lshl_b32 s32, s26, 9
    v_add_u32 v12, s32, v4
    v_add_u32 v18, s32, v5
    ds_read2_b32 v[24:25], v12 offset0:2 offset1:18
    ds_read2_b32 v[26:27], v12 offset0:34 offset1:50
    ds_read2_b32 v[28:29], v12 offset0:66 offset1:82
    ds_read2_b32 v[30:31], v12 offset0:98 offset1:114
    ds_read2_b32 v[16:17], v18 offset0:3 offset1:67
    s_branch M_goi
M_parti:
    s_mov_b32 s26, 0
    s_cmp_eq_u32 s29, 8
    s_cbranch_scc1 M_fulli
    s_cmp_eq_u32 s29, 0
    s_cbranch_scc1 M_wi_0
    buffer_load_dwordx4 v[104:107], v24, s[4:7], s25 offen
    s_cmp_eq_u32 s29, 1
    s_cbranch_scc1 M_wi_1
    buffer_load_dwordx4 v[108:111], v25, s[4:7], s25 offen
    s_cmp_eq_u32 s29, 2
    s_cbranch_scc1 M_wi_2
    buffer_load_dwordx4 v[112:115], v26, s[4:7], s25 offen
    s_cmp_eq_u32 s29, 3
    s_cbranch_scc1 M_wi_3
    buffer_load_dwordx4 v[116:119], v27, s[4:7], s25 offen
    s_cmp_eq_u32 s29, 4
    s_cbranch_scc1 M_wi_4
    buffer_load_dwordx4 v[120:123], v28, s[4:7], s25 offen
    s_cmp_eq_u32 s29, 5
    s_cbranch_scc1 M_wi_5
    buffer_load_dwordx4 v[124:127], v29, s[4:7], s25 offen
    s_cmp_eq_u32 s29, 6
    s_cbranch_scc1 M_wi_6
    buffer_load_dwordx4 v[128:131], v30, s[4:7], s25 offen
M_wi_7:
M_wi_6:
M_wi_5:
M_wi_4:
M_wi_3:
M_wi_2:
M_wi_1:
M_wi_0:
M_pmi:
    s_lshl_b32 s32, s26, 9
    v_add_u32 v12, s32, v4
    v_add_u32 v18, s32, v5
    ds_read2_b32 v[24:25], v12 offset0:2 offset1:18
    ds_read2_b32 v[26:27], v12 offset0:34 offset1:50
    ds_read2_b32 v[28:29], v12 offset0:66 offset1:82
    ds_read2_b32 v[30:31], v12 offset0:98 offset1:114
    ds_read2_b32 v[16:17], v18 offset0:3 offset1:67
M_goi:
    s_mov_b32 s24, s26
    s_cmp_eq_u32 s26, 0
    s_cselect_b32 s32, 256, 0
    s_add_u32 s25, s25, s32
    s_mov_b32 s63, 1
M_it0:
    s_waitcnt lgkmcnt(0)
    s_cmp_eq_u32 s25, 1024
    s_cbranch_scc1 M_w0_0
    v_pk_add_f32 v[24:25], v[24:25], v[2:3]
    v_pk_add_f32 v[26:27], v[26:27], v[2:3]
    v_pk_add_f32 v[28:29], v[28:29], v[2:3]
    v_pk_add_f32 v[30:31], v[30:31], v[2:3]
    v_bfe_i32 v16, v16, v1, 1
    v_bfe_i32 v17, v17, v1, 1
    s_add_u32 s26, s24, 1
    v_and_b32 v16, v16, v18
    v_and_b32 v17, v17, v18
    s_cmp_eq_u32 s26, s23
    ds_read_b64_tr_b16 v[36:37], v16
    ds_read_b64_tr_b16 v[38:39], v17 offset:256
    s_cbranch_scc1 M_part0
M_full0:
    buffer_load_dwordx4 v[136:139], v24, s[4:7], s25 offen
    buffer_load_dwordx4 v[140:143], v25, s[4:7], s25 offen
    buffer_load_dwordx4 v[144:147], v26, s[4:7], s25 offen
    buffer_load_dwordx4 v[148:151], v27, s[4:7], s25 offen
    buffer_load_dwordx4 v[152:155], v28, s[4:7], s25 offen
    buffer_load_dwordx4 v[156:159], v29, s[4:7], s25 offen
    buffer_load_dwordx4 v[160:163], v30, s[4:7], s25 offen
    buffer_load_dwordx4 v[164:167], v31, s[4:7], s25 offen
    s_lshl_b32 s32, s26, 9
    v_add_u32 v12, s32, v4
    v_add_u32 v18, s32, v5
    ds_read2_b32 v[24:25], v12 offset0:2 offset1:18
    ds_read2_b32 v[26:27], v12 offset0:34 offset1:50
    ds_read2_b32 v[28:29], v12 offset0:66 offset1:82
    ds_read2_b32 v[30:31], v12 offset0:98 offset1:114
    ds_read2_b32 v[16:17], v18 offset0:3 offset1:67
    s_waitcnt vmcnt(8)
    s_branch M_go0
M_part0:
    s_mov_b32 s26, 0
    s_cmp_eq_u32 s29, 8
    s_cbranch_scc1 M_full0
    s_cmp_eq_u32 s29, 0
    s_cbranch_scc1 M_w0_0
    buffer_load_dwordx4 v[136:139], v24, s[4:7], s25 offen
    s_cmp_eq_u32 s29, 1
    s_cbranch_scc1 M_w0_1
    buffer_load_dwordx4 v[140:143], v25, s[4:7], s25 offen
    s_cmp_eq_u32 s29, 2
    s_cbranch_scc1 M_w0_2
    buffer_load_dwordx4 v[144:147], v26, s[4:7], s25 offen
    s_cmp_eq_u32 s29, 3
    s_cbranch_scc1 M_w0_3
    buffer_load_dwordx4 v[148:151], v27, s[4:7], s25 offen
    s_cmp_eq_u32 s29, 4
    s_cbranch_scc1 M_w0_4
    buffer_load_dwordx4 v[152:155], v28, s[4:7], s25 offen
    s_cmp_eq_u32 s29, 5
    s_cbranch_scc1 M_w0_5
    buffer_load_dwordx4 v[156:159], v29, s[4:7], s25 offen
    s_cmp_eq_u32 s29, 6
    s_cbranch_scc1 M_w0_6
    buffer_load_dwordx4 v[160:163], v30, s[4:7], s25 offen
M_w0_7:
    s_waitcnt vmcnt(7)
    s_branch M_pm0
M_w0_6:
    s_waitcnt vmcnt(6)
    s_branch M_pm0
M_w0_5:
    s_waitcnt vmcnt(5)
    s_branch M_pm0
M_w0_4:
    s_waitcnt vmcnt(4)
    s_branch M_pm0
M_w0_3:
    s_waitcnt vmcnt(3)
    s_branch M_pm0
M_w0_2:
    s_waitcnt vmcnt(2)
    s_branch M_pm0
M_w0_1:
    s_waitcnt vmcnt(1)
    s_branch M_pm0
M_w0_0:
    s_waitcnt vmcnt(0)
M_pm0:
    s_lshl_b32 s32, s26, 9
    v_add_u32 v12, s32, v4
    v_add_u32 v18, s32, v5
    ds_read2_b32 v[24:25], v12 offset0:2 offset1:18
    ds_read2_b32 v[26:27], v12 offset0:34 offset1:50
    ds_read2_b32 v[28:29], v12 offset0:66 offset1:82
    ds_read2_b32 v[30:31], v12 offset0:98 offset1:114
    ds_read2_b32 v[16:17], v18 offset0:3 offset1:67
M_go0:
    s_cmp_eq_u32 s63, 0
    s_cbranch_scc1 M_cn0
    v_perm_b32 v40, v108, v104, s27
    v_perm_b32 v41, v116, v112, s27
    v_perm_b32 v42, v124, v120, s27
    v_perm_b32 v43, v132, v128, s27
    v_perm_b32 v44, v108, v104, s28
    v_perm_b32 v45, v116, v112, s28
    v_perm_b32 v46, v124, v120, s28
    v_perm_b32 v47, v132, v128, s28
    v_mfma_f32_16x16x32_bf16 v[48:51], v[32:35], v[40:43], 0
    v_perm_b32 v40, v109, v105, s27
    v_perm_b32 v41, v117, v113, s27
    v_perm_b32 v42, v125, v121, s27
    v_perm_b32 v43, v133, v129, s27
    v_mfma_f32_16x16x32_bf16 v[52:55], v[32:35], v[44:47], 0
    v_perm_b32 v44, v109, v105, s28
    v_perm_b32 v45, v117, v113, s28
    v_perm_b32 v46, v125, v121, s28
    v_perm_b32 v47, v133, v129, s28
    v_mfma_f32_16x16x32_bf16 v[56:59], v[32:35], v[40:43], 0
    v_perm_b32 v40, v110, v106, s27
    v_perm_b32 v41, v118, v114, s27
    v_perm_b32 v42, v126, v122, s27
    v_perm_b32 v43, v134, v130, s27
    v_mfma_f32_16x16x32_bf16 v[60:63], v[32:35], v[44:47], 0
    v_perm_b32 v44, v110, v106, s28
    v_perm_b32 v45, v118, v114, s28
    v_perm_b32 v46, v126, v122, s28
    v_perm_b32 v47, v134, v130, s28
    v_mfma_f32_16x16x32_bf16 v[64:67], v[32:35], v[40:43], 0
    v_perm_b32 v40, v111, v107, s27
    v_perm_b32 v41, v119, v115, s27
    v_perm_b32 v42, v127, v123, s27
    v_perm_b32 v43, v135, v131, s27
    v_mfma_f32_16x16x32_bf16 v[68:71], v[32:35], v[44:47], 0
    v_perm_b32 v44, v111, v107, s28
    v_perm_b32 v45, v119, v115, s28
    v_perm_b32 v46, v127, v123, s28
    v_perm_b32 v47, v135, v131, s28
    v_mfma_f32_16x16x32_bf16 v[72:75], v[32:35], v[40:43], 0
    s_nop 1
    v_mfma_f32_16x16x32_bf16 v[76:79], v[32:35], v[44:47], 0
    s_branch M_cd0
M_cn0:
    v_perm_b32 v40, v108, v104, s27
    v_perm_b32 v41, v116, v112, s27
    v_perm_b32 v42, v124, v120, s27
    v_perm_b32 v43, v132, v128, s27
    v_perm_b32 v44, v108, v104, s28
    v_perm_b32 v45, v116, v112, s28
    v_perm_b32 v46, v124, v120, s28
    v_perm_b32 v47, v132, v128, s28
    v_mfma_f32_16x16x32_bf16 v[48:51], v[32:35], v[40:43], v[48:51]
    v_perm_b32 v40, v109, v105, s27
    v_perm_b32 v41, v117, v113, s27
    v_perm_b32 v42, v125, v121, s27
    v_perm_b32 v43, v133, v129, s27
    v_mfma_f32_16x16x32_bf16 v[52:55], v[32:35], v[44:47], v[52:55]
    v_perm_b32 v44, v109, v105, s28
    v_perm_b32 v45, v117, v113, s28
    v_perm_b32 v46, v125, v121, s28
    v_perm_b32 v47, v133, v129, s28
    v_mfma_f32_16x16x32_bf16 v[56:59], v[32:35], v[40:43], v[56:59]
    v_perm_b32 v40, v110, v106, s27
    v_perm_b32 v41, v118, v114, s27
    v_perm_b32 v42, v126, v122, s27
    v_perm_b32 v43, v134, v130, s27
    v_mfma_f32_16x16x32_bf16 v[60:63], v[32:35], v[44:47], v[60:63]
    v_perm_b32 v44, v110, v106, s28
    v_perm_b32 v45, v118, v114, s28
    v_perm_b32 v46, v126, v122, s28
    v_perm_b32 v47, v134, v130, s28
    v_mfma_f32_16x16x32_bf16 v[64:67], v[32:35], v[40:43], v[64:67]
    v_perm_b32 v40, v111, v107, s27
    v_perm_b32 v41, v119, v115, s27
    v_perm_b32 v42, v127, v123, s27
    v_perm_b32 v43, v135, v131, s27
    v_mfma_f32_16x16x32_bf16 v[68:71], v[32:35], v[44:47], v[68:71]
    v_perm_b32 v44, v111, v107, s28
    v_perm_b32 v45, v119, v115, s28
    v_perm_b32 v46, v127, v123, s28
    v_perm_b32 v47, v135, v131, s28
    v_mfma_f32_16x16x32_bf16 v[72:75], v[32:35], v[40:43], v[72:75]
    s_nop 1
    v_mfma_f32_16x16x32_bf16 v[76:79], v[32:35], v[44:47], v[76:79]
M_cd0:
    s_mov_b32 s63, 0
    s_cmp_lg_u32 s24, 0
    s_cbranch_scc1 M_nofl0
    s_mov_b32 s63, 1
    s_call_b64 s[60:61], M_flush
    s_cmp_eq_u32 s25, 1024
    s_cbranch_scc1 M_end
M_nofl0:
    s_mov_b32 s24, s26
    s_cmp_eq_u32 s26, 0
    s_cselect_b32 s32, 256, 0
    s_add_u32 s25, s25, s32
M_it1:
    s_waitcnt lgkmcnt(0)
    s_cmp_eq_u32 s25, 1024
    s_cbranch_scc1 M_w1_0
    v_pk_add_f32 v[24:25], v[24:25], v[2:3]
    v_pk_add_f32 v[26:27], v[26:27], v[2:3]
    v_pk_add_f32 v[28:29], v[28:29], v[2:3]
    v_pk_add_f32 v[30:31], v[30:31], v[2:3]
    v_bfe_i32 v16, v16, v1, 1
    v_bfe_i32 v17, v17, v1, 1
    s_add_u32 s26, s24, 1
    v_and_b32 v16, v16, v18
    v_and_b32 v17, v17, v18
    s_cmp_eq_u32 s26, s23
    ds_read_b64_tr_b16 v[32:33], v16
    ds_read_b64_tr_b16 v[34:35], v17 offset:256
    s_cbranch_scc1 M_part1
M_full1:
    buffer_load_dwordx4 v[104:107], v24, s[4:7], s25 offen
    buffer_load_dwordx4 v[108:111], v25, s[4:7], s25 offen
    buffer_load_dwordx4 v[112:115], v26, s[4:7], s25 offen
    buffer_load_dwordx4 v[116:119], v27, s[4:7], s25 offen
    buffer_load_dwordx4 v[120:123], v28, s[4:7], s25 offen
    buffer_load_dwordx4 v[124:127], v29, s[4:7], s25 offen
    buffer_load_dwordx4 v[128:131], v30, s[4:7], s25 offen
    buffer_load_dwordx4 v[132:135], v31, s[4:7], s25 offen
    s_lshl_b32 s32, s26, 9
    v_add_u32 v12, s32, v4
    v_add_u32 v18, s32, v5
    ds_read2_b32 v[24:25], v12 offset0:2 offset1:18
    ds_read2_b32 v[26:27], v12 offset0:34 offset1:50
    ds_read2_b32 v[28:29], v12 offset0:66 offset1:82
    ds_read2_b32 v[30:31], v12 offset0:98 offset1:114
    ds_read2_b32 v[16:17], v18 offset0:3 offset1:67
    s_waitcnt vmcnt(8)
    s_branch M_go1
M_part1:
    s_mov_b32 s26, 0
    s_cmp_eq_u32 s29, 8
    s_cbranch_scc1 M_full1
    s_cmp_eq_u32 s29, 0
    s_cbranch_scc1 M_w1_0
    buffer_load_dwordx4 v[104:107], v24, s[4:7], s25 offen
    s_cmp_eq_u32 s29, 1
    s_cbranch_scc1 M_w1_1
    buffer_load_dwordx4 v[108:111], v25, s[4:7], s25 offen
    s_cmp_eq_u32 s29, 2
    s_cbranch_scc1 M_w1_2
    buffer_load_dwordx4 v[112:115], v26, s[4:7], s25 offen
    s_cmp_eq_u32 s29, 3
    s_cbranch_scc1 M_w1_3
    buffer_load_dwordx4 v[116:119], v27, s[4:7], s25 offen
    s_cmp_eq_u32 s29, 4
    s_cbranch_scc1 M_w1_4
    buffer_load_dwordx4 v[120:123], v28, s[4:7], s25 offen
    s_cmp_eq_u32 s29, 5
    s_cbranch_scc1 M_w1_5
    buffer_load_dwordx4 v[124:127], v29, s[4:7], s25 offen
    s_cmp_eq_u32 s29, 6
    s_cbranch_scc1 M_w1_6
    buffer_load_dwordx4 v[128:131], v30, s[4:7], s25 offen
M_w1_7:
    s_waitcnt vmcnt(7)
    s_branch M_pm1
M_w1_6:
    s_waitcnt vmcnt(6)
    s_branch M_pm1
M_w1_5:
    s_waitcnt vmcnt(5)
    s_branch M_pm1
M_w1_4:
    s_waitcnt vmcnt(4)
    s_branch M_pm1
M_w1_3:
    s_waitcnt vmcnt(3)
    s_branch M_pm1
M_w1_2:
    s_waitcnt vmcnt(2)
    s_branch M_pm1
M_w1_1:
    s_waitcnt vmcnt(1)
    s_branch M_pm1
M_w1_0:
    s_waitcnt vmcnt(0)
M_pm1:
    s_lshl_b32 s32, s26, 9
    v_add_u32 v12, s32, v4
    v_add_u32 v18, s32, v5
    ds_read2_b32 v[24:25], v12 offset0:2 offset1:18
    ds_read2_b32 v[26:27], v12 offset0:34 offset1:50
    ds_read2_b32 v[28:29], v12 offset0:66 offset1:82
    ds_read2_b32 v[30:31], v12 offset0:98 offset1:114
    ds_read2_b32 v[16:17], v18 offset0:3 offset1:67
M_go1:
    s_cmp_eq_u32 s63, 0
    s_cbranch_scc1 M_cn1
    v_perm_b32 v40, v140, v136, s27
    v_perm_b32 v41, v148, v144, s27
    v_perm_b32 v42, v156, v152, s27
    v_perm_b32 v43, v164, v160, s27
    v_perm_b32 v44, v140, v136, s28
    v_perm_b32 v45, v148, v144, s28
    v_perm_b32 v46, v156, v152, s28
    v_perm_b32 v47, v164, v160, s28
    v_mfma_f32_16x16x32_bf16 v[48:51], v[36:39], v[40:43], 0
    v_perm_b32 v40, v141, v137, s27
    v_perm_b32 v41, v149, v145, s27
    v_perm_b32 v42, v157, v153, s27
    v_perm_b32 v43, v165, v161, s27
    v_mfma_f32_16x16x32_bf16 v[52:55], v[36:39], v[44:47], 0
    v_perm_b32 v44, v141, v137, s28
    v_perm_b32 v45, v149, v145, s28
    v_perm_b32 v46, v157, v153, s28
    v_perm_b32 v47, v165, v161, s28
    v_mfma_f32_16x16x32_bf16 v[56:59], v[36:39], v[40:43], 0
    v_perm_b32 v40, v142, v138, s27
    v_perm_b32 v41, v150, v146, s27
    v_perm_b32 v42, v158, v154, s27
    v_perm_b32 v43, v166, v162, s27
    v_mfma_f32_16x16x32_bf16 v[60:63], v[36:39], v[44:47], 0
    v_perm_b32 v44, v142, v138, s28
    v_perm_b32 v45, v150, v146, s28
    v_perm_b32 v46, v158, v154, s28
    v_perm_b32 v47, v166, v162, s28
    v_mfma_f32_16x16x32_bf16 v[64:67], v[36:39], v[40:43], 0
    v_perm_b32 v40, v143, v139, s27
    v_perm_b32 v41, v151, v147, s27
    v_perm_b32 v42, v159, v155, s27
    v_perm_b32 v43, v167, v163, s27
    v_mfma_f32_16x16x32_bf16 v[68:71], v[36:39], v[44:47], 0
    v_perm_b32 v44, v143, v139, s28
    v_perm_b32 v45, v151, v147, s28
    v_perm_b32 v46, v159, v155, s28
    v_perm_b32 v47, v167, v163, s28
    v_mfma_f32_16x16x32_bf16 v[72:75], v[36:39], v[40:43], 0
    s_nop 1
    v_mfma_f32_16x16x32_bf16 v[76:79], v[36:39], v[44:47], 0
    s_branch M_cd1
M_cn1:
    v_perm_b32 v40, v140, v136, s27
    v_perm_b32 v41, v148, v144, s27
    v_perm_b32 v42, v156, v152, s27
    v_perm_b32 v43, v164, v160, s27
    v_perm_b32 v44, v140, v136, s28
    v_perm_b32 v45, v148, v144, s28
    v_perm_b32 v46, v156, v152, s28
    v_perm_b32 v47, v164, v160, s28
    v_mfma_f32_16x16x32_bf16 v[48:51], v[36:39], v[40:43], v[48:51]
    v_perm_b32 v40, v141, v137, s27
    v_perm_b32 v41, v149, v145, s27
    v_perm_b32 v42, v157, v153, s27
    v_perm_b32 v43, v165, v161, s27
    v_mfma_f32_16x16x32_bf16 v[52:55], v[36:39], v[44:47], v[52:55]
    v_perm_b32 v44, v141, v137, s28
    v_perm_b32 v45, v149, v145, s28
    v_perm_b32 v46, v157, v153, s28
    v_perm_b32 v47, v165, v161, s28
    v_mfma_f32_16x16x32_bf16 v[56:59], v[36:39], v[40:43], v[56:59]
    v_perm_b32 v40, v142, v138, s27
    v_perm_b32 v41, v150, v146, s27
    v_perm_b32 v42, v158, v154, s27
    v_perm_b32 v43, v166, v162, s27
    v_mfma_f32_16x16x32_bf16 v[60:63], v[36:39], v[44:47], v[60:63]
    v_perm_b32 v44, v142, v138, s28
    v_perm_b32 v45, v150, v146, s28
    v_perm_b32 v46, v158, v154, s28
    v_perm_b32 v47, v166, v162, s28
    v_mfma_f32_16x16x32_bf16 v[64:67], v[36:39], v[40:43], v[64:67]
    v_perm_b32 v40, v143, v139, s27
    v_perm_b32 v41, v151, v147, s27
    v_perm_b32 v42, v159, v155, s27
    v_perm_b32 v43, v167, v163, s27
    v_mfma_f32_16x16x32_bf16 v[68:71], v[36:39], v[44:47], v[68:71]
    v_perm_b32 v44, v143, v139, s28
    v_perm_b32 v45, v151, v147, s28
    v_perm_b32 v46, v159, v155, s28
    v_perm_b32 v47, v167, v163, s28
    v_mfma_f32_16x16x32_bf16 v[72:75], v[36:39], v[40:43], v[72:75]
    s_nop 1
    v_mfma_f32_16x16x32_bf16 v[76:79], v[36:39], v[44:47], v[76:79]
M_cd1:
    s_mov_b32 s63, 0
    s_cmp_lg_u32 s24, 0
    s_cbranch_scc1 M_nofl1
    s_mov_b32 s63, 1
    s_call_b64 s[60:61], M_flush
    s_cmp_eq_u32 s25, 1024
    s_cbranch_scc1 M_end
M_nofl1:
    s_mov_b32 s24, s26
    s_cmp_eq_u32 s26, 0
    s_cselect_b32 s32, 256, 0
    s_add_u32 s25, s25, s32
    s_branch M_it0
M_sglb:
    s_mov_b32 s63, 0
    v_pk_add_f32 v[24:25], v[24:25], v[2:3]
    v_pk_add_f32 v[26:27], v[26:27], v[2:3]
    v_pk_add_f32 v[28:29], v[28:29], v[2:3]
    v_pk_add_f32 v[30:31], v[30:31], v[2:3]
    v_bfe_i32 v16, v16, v1, 1
    v_bfe_i32 v17, v17, v1, 1
    v_and_b32 v16, v16, v18
    v_and_b32 v17, v17, v18
M_its:
    s_add_u32 s26, s24, 1
    s_cmp_eq_u32 s26, s23
    s_cbranch_scc1 M_parts
M_fulls:
    buffer_load_dwordx4 v[104:107], v24, s[4:7], s25 offen
    buffer_load_dwordx4 v[108:111], v25, s[4:7], s25 offen
    buffer_load_dwordx4 v[112:115], v26, s[4:7], s25 offen
    buffer_load_dwordx4 v[116:119], v27, s[4:7], s25 offen
    buffer_load_dwordx4 v[120:123], v28, s[4:7], s25 offen
    buffer_load_dwordx4 v[124:127], v29, s[4:7], s25 offen
    buffer_load_dwordx4 v[128:131], v30, s[4:7], s25 offen
    buffer_load_dwordx4 v[132:135], v31, s[4:7], s25 offen
    s_branch M_pms
M_parts:
    s_mov_b32 s26, 0
    s_cmp_eq_u32 s29, 8
    s_cbranch_scc1 M_fulls
    s_cmp_eq_u32 s29, 0
    s_cbranch_scc1 M_pms
    buffer_load_dwordx4 v[104:107], v24, s[4:7], s25 offen
    s_cmp_eq_u32 s29, 1
    s_cbranch_scc1 M_pms
    buffer_load_dwordx4 v[108:111], v25, s[4:7], s25 offen
    s_cmp_eq_u32 s29, 2
    s_cbranch_scc1 M_pms
    buffer_load_dwordx4 v[112:115], v26, s[4:7], s25 offen
    s_cmp_eq_u32 s29, 3
    s_cbranch_scc1 M_pms
    buffer_load_dwordx4 v[116:119], v27, s[4:7], s25 offen
    s_cmp_eq_u32 s29, 4
    s_cbranch_scc1 M_pms
    buffer_load_dwordx4 v[120:123], v28, s[4:7], s25 offen
    s_cmp_eq_u32 s29, 5
    s_cbranch_scc1 M_pms
    buffer_load_dwordx4 v[124:127], v29, s[4:7], s25 offen
    s_cmp_eq_u32 s29, 6
    s_cbranch_scc1 M_pms
    buffer_load_dwordx4 v[128:131], v30, s[4:7], s25 offen
M_pms:
    ds_read_b64_tr_b16 v[32:33], v16
    ds_read_b64_tr_b16 v[34:35], v17 offset:256
    s_lshl_b32 s32, s26, 9
    v_add_u32 v12, s32, v4
    v_add_u32 v18, s32, v5
    ds_read2_b32 v[24:25], v12 offset0:2 offset1:18
    ds_read2_b32 v[26:27], v12 offset0:34 offset1:50
    ds_read2_b32 v[28:29], v12 offset0:66 offset1:82
    ds_read2_b32 v[30:31], v12 offset0:98 offset1:114
    ds_read2_b32 v[16:17], v18 offset0:3 offset1:67
    s_cmp_eq_u32 s63, 0
    s_cbranch_scc1 M_nofls
M_dofl:
    s_call_b64 s[60:61], M_flush
    s_cmp_eq_u32 s25, 1024
    s_cbranch_scc1 M_end
    s_cmp_lg_u32 s25, 512
    s_cbranch_scc1 M_nofls
    s_cmp_lg_u32 s31, 0
    s_cbranch_scc1 M_nofls
    s_cmp_lg_u32 s1, 0
    s_cbranch_scc1 M_midw
    s_sub_u32 s32, s22, 4
    s_mul_i32 s32, s32, 20480
    s_lshl_b32 s33, s2, 2
    s_add_u32 s32, s32, s33
    s_add_u32 s32, s32, 6553600
    v_and_b32 v12, 63, v0
    v_min_u32 v12, 19, v12
    v_lshl_add_u32 v12, v12, 10, s32
M_wfchkm:
    global_load_dword v13, v12, s[68:69] sc1
    s_waitcnt vmcnt(0)
    v_cmp_eq_u32 vcc, s64, v13
    s_cmp_eq_u64 vcc, -1
    s_cbranch_scc1 M_wfldm
    s_sub_u32 s0, s0, 1
    s_cmp_gt_i32 s0, 0
    s_cbranch_scc1 M_wfchkm
M_wfldm:
    s_sub_u32 s38, s22, 4
    s_mul_i32 s38, s38, 20480
    v_and_b32 v12, 63, v0
    v_lshl_add_u32 v12, v12, 4, s38
    global_load_dwordx4 v[136:139], v12, s[20:21] offset:0 sc1
    global_load_dwordx4 v[140:143], v12, s[20:21] offset:1024 sc1
    global_load_dwordx4 v[144:147], v12, s[20:21] offset:2048 sc1
    global_load_dwordx4 v[148:151], v12, s[20:21] offset:3072 sc1
    v_add_u32 v12, 8192, v12
    global_load_dwordx4 v[152:155], v12, s[20:21] offset:0 sc1
    global_load_dwordx4 v[156:159], v12, s[20:21] offset:1024 sc1
    global_load_dwordx4 v[160:163], v12, s[20:21] offset:2048 sc1
    global_load_dwordx4 v[164:167], v12, s[20:21] offset:3072 sc1
    s_waitcnt vmcnt(0)
    s_mov_b32 s1, 1
M_midw:
    v_mov_b32 v14, 2136
    ds_read_b32 v15, v14
    v_and_b32 v12, 15, v0
    v_bfe_u32 v13, v0, 4, 2
    v_mul_u32_u24 v19, 2816, v12
    v_xor_b32 v7, v13, v12
    v_lshl_add_u32 v7, v7, 4, v19
    v_add_u32 v7, 2304, v7
    v_lshrrev_b32 v19, 3, v12
    v_mul_i32_i24 v19, -21760, v19
M_midf:
    s_waitcnt lgkmcnt(0)
    v_readfirstlane_b32 s32, v15
    s_cmp_ge_u32 s32, 12
    s_cbranch_scc1 M_midg
    s_sleep 1
    ds_read_b32 v15, v14
    s_sub_u32 s50, s50, 1
    s_cmp_gt_i32 s50, 0
    s_cbranch_scc1 M_midf
    s_waitcnt lgkmcnt(0)
M_midg:
    v_xor_b32 v12, 0, v7
    v_add_u32 v13, 90112, v12
    ds_read_b128 v[40:43], v12 offset:0
    ds_read_b128 v[44:47], v12 offset:45056
    ds_read_b128 v[64:67], v13 offset:0
    v_xor_b32 v12, 64, v7
    v_add_u32 v13, 90112, v12
    ds_read_b128 v[68:71], v12 offset:0
    ds_read_b128 v[72:75], v12 offset:45056
    ds_read_b128 v[76:79], v13 offset:0
    s_waitcnt lgkmcnt(5)
    v_mfma_f32_16x16x32_bf16 v[8:11], v[136:139], v[40:43], 0
    v_xor_b32 v12, 128, v7
    v_add_u32 v13, 90112, v12
    ds_read_b128 v[40:43], v12 offset:0
    s_waitcnt lgkmcnt(5)
    v_mfma_f32_16x16x32_bf16 v[20:23], v[136:139], v[44:47], 0
    ds_read_b128 v[44:47], v12 offset:45056
    s_waitcnt lgkmcnt(5)
    v_mfma_f32_16x16x32_bf16 v[36:39], v[136:139], v[64:67], 0
    ds_read_b128 v[64:67], v13 offset:0
    s_waitcnt lgkmcnt(5)
    v_mfma_f32_16x16x32_bf16 v[8:11], v[140:143], v[68:71], v[8:11]
    v_xor_b32 v12, 192, v7
    v_add_u32 v13, 90112, v12
    ds_read_b128 v[68:71], v12 offset:0
    s_waitcnt lgkmcnt(5)
    v_mfma_f32_16x16x32_bf16 v[20:23], v[140:143], v[72:75], v[20:23]
    ds_read_b128 v[72:75], v12 offset:45056
    s_waitcnt lgkmcnt(5)
    v_mfma_f32_16x16x32_bf16 v[36:39], v[140:143], v[76:79], v[36:39]
    ds_read_b128 v[76:79], v13 offset:0
    s_waitcnt lgkmcnt(5)
    v_mfma_f32_16x16x32_bf16 v[8:11], v[144:147], v[40:43], v[8:11]
    v_xor_b32 v12, 0, v7
    v_add_u32 v13, 90112, v12
    v_add_u32 v14, v13, v19
    ds_read_b128 v[40:43], v12 offset:46336
    s_waitcnt lgkmcnt(5)
    v_mfma_f32_16x16x32_bf16 v[20:23], v[144:147], v[44:47], v[20:23]
    ds_read_b128 v[44:47], v12 offset:47104
    s_waitcnt lgkmcnt(5)
    v_mfma_f32_16x16x32_bf16 v[36:39], v[144:147], v[64:67], v[36:39]
    ds_read_b128 v[64:67], v14 offset:512
    s_waitcnt lgkmcnt(5)
    v_mfma_f32_16x16x32_bf16 v[8:11], v[148:151], v[68:71], v[8:11]
    ds_read_b128 v[68:71], v13 offset:2048
    s_waitcnt lgkmcnt(5)
    v_mfma_f32_16x16x32_bf16 v[20:23], v[148:151], v[72:75], v[20:23]
    ds_read_b128 v[72:75], v12 offset:512
    s_waitcnt lgkmcnt(5)
    v_mfma_f32_16x16x32_bf16 v[36:39], v[148:151], v[76:79], v[36:39]
    ds_read_b128 v[76:79], v12 offset:1280
    s_waitcnt lgkmcnt(5)
    v_mfma_f32_16x16x32_bf16 v[48:51], v[152:155], v[40:43], 0
    ds_read_b128 v[40:43], v12 offset:2048
    s_waitcnt lgkmcnt(5)
    v_mfma_f32_16x16x32_bf16 v[52:55], v[152:155], v[44:47], 0
    ds_read_b128 v[44:47], v12 offset:45568
    s_waitcnt lgkmcnt(5)
    v_mfma_f32_16x16x32_bf16 v[56:59], v[152:155], v[64:67], 0
    v_xor_b32 v12, 64, v7
    v_add_u32 v13, 90112, v12
    v_add_u32 v14, v13, v19
    ds_read_b128 v[64:67], v12 offset:46336
    s_waitcnt lgkmcnt(5)
    v_mfma_f32_16x16x32_bf16 v[60:63], v[152:155], v[68:71], 0
    ds_read_b128 v[68:71], v12 offset:47104
    s_waitcnt lgkmcnt(5)
    v_mfma_f32_16x16x32_bf16 v[136:139], v[152:155], v[72:75], 0
    ds_read_b128 v[72:75], v14 offset:512
    s_waitcnt lgkmcnt(5)
    v_mfma_f32_16x16x32_bf16 v[140:143], v[152:155], v[76:79], 0
    ds_read_b128 v[76:79], v13 offset:2048
    s_waitcnt lgkmcnt(5)
    v_mfma_f32_16x16x32_bf16 v[144:147], v[152:155], v[40:43], 0
    ds_read_b128 v[40:43], v12 offset:512
    s_waitcnt lgkmcnt(5)
    v_mfma_f32_16x16x32_bf16 v[148:151], v[152:155], v[44:47], 0
    ds_read_b128 v[44:47], v12 offset:1280
    s_waitcnt lgkmcnt(5)
    v_mfma_f32_16x16x32_bf16 v[48:51], v[156:159], v[64:67], v[48:51]
    ds_read_b128 v[64:67], v12 offset:2048
    s_waitcnt lgkmcnt(5)
    v_mfma_f32_16x16x32_bf16 v[52:55], v[156:159], v[68:71], v[52:55]
    ds_read_b128 v[68:71], v12 offset:45568
    s_waitcnt lgkmcnt(5)
    v_mfma_f32_16x16x32_bf16 v[56:59], v[156:159], v[72:75], v[56:59]
    v_xor_b32 v12, 128, v7
    v_add_u32 v13, 90112, v12
    v_add_u32 v14, v13, v19
    ds_read_b128 v[72:75], v12 offset:46336
    s_waitcnt lgkmcnt(5)
    v_mfma_f32_16x16x32_bf16 v[60:63], v[156:159], v[76:79], v[60:63]
    ds_read_b128 v[76:79], v12 offset:47104
    s_waitcnt lgkmcnt(5)
    v_mfma_f32_16x16x32_bf16 v[136:139], v[156:159], v[40:43], v[136:139]
    ds_read_b128 v[40:43], v14 offset:512
    s_waitcnt lgkmcnt(5)
    v_mfma_f32_16x16x32_bf16 v[140:143], v[156:159], v[44:47], v[140:143]
    ds_read_b128 v[44:47], v13 offset:2048
    s_waitcnt lgkmcnt(5)
    v_mfma_f32_16x16x32_bf16 v[144:147], v[156:159], v[64:67], v[144:147]
    ds_read_b128 v[64:67], v12 offset:512
    s_waitcnt lgkmcnt(5)
    v_mfma_f32_16x16x32_bf16 v[148:151], v[156:159], v[68:71], v[148:151]
    ds_read_b128 v[68:71], v12 offset:1280
    s_waitcnt lgkmcnt(5)
    v_mfma_f32_16x16x32_bf16 v[48:51], v[160:163], v[72:75], v[48:51]
    ds_read_b128 v[72:75], v12 offset:2048
    s_waitcnt lgkmcnt(5)
    v_mfma_f32_16x16x32_bf16 v[52:55], v[160:163], v[76:79], v[52:55]
    ds_read_b128 v[76:79], v12 offset:45568
    s_waitcnt lgkmcnt(5)
    v_mfma_f32_16x16x32_bf16 v[56:59], v[160:163], v[40:43], v[56:59]
    v_xor_b32 v12, 192, v7
    v_add_u32 v13, 90112, v12
    v_add_u32 v14, v13, v19
    ds_read_b128 v[40:43], v12 offset:46336
    s_waitcnt lgkmcnt(5)
    v_mfma_f32_16x16x32_bf16 v[60:63], v[160:163], v[44:47], v[60:63]
    ds_read_b128 v[44:47], v12 offset:47104
    s_waitcnt lgkmcnt(5)
    v_mfma_f32_16x16x32_bf16 v[136:139], v[160:163], v[64:67], v[136:139]
    ds_read_b128 v[64:67], v14 offset:512
    s_waitcnt lgkmcnt(5)
    v_mfma_f32_16x16x32_bf16 v[140:143], v[160:163], v[68:71], v[140:143]
    ds_read_b128 v[68:71], v13 offset:2048
    s_waitcnt lgkmcnt(5)
    v_mfma_f32_16x16x32_bf16 v[144:147], v[160:163], v[72:75], v[144:147]
    ds_read_b128 v[72:75], v12 offset:512
    s_waitcnt lgkmcnt(5)
    v_mfma_f32_16x16x32_bf16 v[148:151], v[160:163], v[76:79], v[148:151]
    ds_read_b128 v[76:79], v12 offset:1280
    s_waitcnt lgkmcnt(5)
    v_mfma_f32_16x16x32_bf16 v[48:51], v[164:167], v[40:43], v[48:51]
    ds_read_b128 v[40:43], v12 offset:2048
    s_waitcnt lgkmcnt(5)
    v_mfma_f32_16x16x32_bf16 v[52:55], v[164:167], v[44:47], v[52:55]
    ds_read_b128 v[44:47], v12 offset:45568
    s_waitcnt lgkmcnt(5)
    v_mfma_f32_16x16x32_bf16 v[56:59], v[164:167], v[64:67], v[56:59]
    s_waitcnt lgkmcnt(4)
    v_mfma_f32_16x16x32_bf16 v[60:63], v[164:167], v[68:71], v[60:63]
    s_waitcnt lgkmcnt(3)
    v_mfma_f32_16x16x32_bf16 v[136:139], v[164:167], v[72:75], v[136:139]
    s_waitcnt lgkmcnt(2)
    v_mfma_f32_16x16x32_bf16 v[140:143], v[164:167], v[76:79], v[140:143]
    s_waitcnt lgkmcnt(1)
    v_mfma_f32_16x16x32_bf16 v[144:147], v[164:167], v[40:43], v[144:147]
    s_waitcnt lgkmcnt(0)
    v_mfma_f32_16x16x32_bf16 v[148:151], v[164:167], v[44:47], v[148:151]
    v_mov_b32 v152, v48
    v_mov_b32 v153, v49
    v_mov_b32 v154, v50
    v_mov_b32 v155, v51
    v_mov_b32 v156, v52
    v_mov_b32 v157, v53
    v_mov_b32 v158, v54
    v_mov_b32 v159, v55
    v_mov_b32 v160, v56
    v_mov_b32 v161, v57
    v_mov_b32 v162, v58
    v_mov_b32 v163, v59
    v_mov_b32 v164, v60
    v_mov_b32 v165, v61
    v_mov_b32 v166, v62
    v_mov_b32 v167, v63
M_nofls:
    s_waitcnt lgkmcnt(0)
    v_pk_add_f32 v[24:25], v[24:25], v[2:3]
    v_pk_add_f32 v[26:27], v[26:27], v[2:3]
    v_pk_add_f32 v[28:29], v[28:29], v[2:3]
    v_pk_add_f32 v[30:31], v[30:31], v[2:3]
    v_bfe_i32 v16, v16, v1, 1
    v_bfe_i32 v17, v17, v1, 1
    v_and_b32 v16, v16, v18
    v_and_b32 v17, v17, v18
    s_cmp_eq_u32 s24, 0
    s_mov_b32 s24, s26
    s_waitcnt vmcnt(0)
    s_cbranch_scc0 M_cns
    v_perm_b32 v40, v108, v104, s27
    v_perm_b32 v41, v116, v112, s27
    v_perm_b32 v42, v124, v120, s27
    v_perm_b32 v43, v132, v128, s27
    v_perm_b32 v44, v108, v104, s28
    v_perm_b32 v45, v116, v112, s28
    v_perm_b32 v46, v124, v120, s28
    v_perm_b32 v47, v132, v128, s28
    v_mfma_f32_16x16x32_bf16 v[48:51], v[32:35], v[40:43], 0
    v_perm_b32 v40, v109, v105, s27
    v_perm_b32 v41, v117, v113, s27
    v_perm_b32 v42, v125, v121, s27
    v_perm_b32 v43, v133, v129, s27
    v_mfma_f32_16x16x32_bf16 v[52:55], v[32:35], v[44:47], 0
    v_perm_b32 v44, v109, v105, s28
    v_perm_b32 v45, v117, v113, s28
    v_perm_b32 v46, v125, v121, s28
    v_perm_b32 v47, v133, v129, s28
    v_mfma_f32_16x16x32_bf16 v[56:59], v[32:35], v[40:43], 0
    v_perm_b32 v40, v110, v106, s27
    v_perm_b32 v41, v118, v114, s27
    v_perm_b32 v42, v126, v122, s27
    v_perm_b32 v43, v134, v130, s27
    v_mfma_f32_16x16x32_bf16 v[60:63], v[32:35], v[44:47], 0
    v_perm_b32 v44, v110, v106, s28
    v_perm_b32 v45, v118, v114, s28
    v_perm_b32 v46, v126, v122, s28
    v_perm_b32 v47, v134, v130, s28
    v_mfma_f32_16x16x32_bf16 v[64:67], v[32:35], v[40:43], 0
    v_perm_b32 v40, v111, v107, s27
    v_perm_b32 v41, v119, v115, s27
    v_perm_b32 v42, v127, v123, s27
    v_perm_b32 v43, v135, v131, s27
    v_mfma_f32_16x16x32_bf16 v[68:71], v[32:35], v[44:47], 0
    v_perm_b32 v44, v111, v107, s28
    v_perm_b32 v45, v119, v115, s28
    v_perm_b32 v46, v127, v123, s28
    v_perm_b32 v47, v135, v131, s28
    v_mfma_f32_16x16x32_bf16 v[72:75], v[32:35], v[40:43], 0
    s_nop 1
    v_mfma_f32_16x16x32_bf16 v[76:79], v[32:35], v[44:47], 0
    s_branch M_cds
M_cns:
    v_perm_b32 v40, v108, v104, s27
    v_perm_b32 v41, v116, v112, s27
    v_perm_b32 v42, v124, v120, s27
    v_perm_b32 v43, v132, v128, s27
    v_perm_b32 v44, v108, v104, s28
    v_perm_b32 v45, v116, v112, s28
    v_perm_b32 v46, v124, v120, s28
    v_perm_b32 v47, v132, v128, s28
    v_mfma_f32_16x16x32_bf16 v[48:51], v[32:35], v[40:43], v[48:51]
    v_perm_b32 v40, v109, v105, s27
    v_perm_b32 v41, v117, v113, s27
    v_perm_b32 v42, v125, v121, s27
    v_perm_b32 v43, v133, v129, s27
    v_mfma_f32_16x16x32_bf16 v[52:55], v[32:35], v[44:47], v[52:55]
    v_perm_b32 v44, v109, v105, s28
    v_perm_b32 v45, v117, v113, s28
    v_perm_b32 v46, v125, v121, s28
    v_perm_b32 v47, v133, v129, s28
    v_mfma_f32_16x16x32_bf16 v[56:59], v[32:35], v[40:43], v[56:59]
    v_perm_b32 v40, v110, v106, s27
    v_perm_b32 v41, v118, v114, s27
    v_perm_b32 v42, v126, v122, s27
    v_perm_b32 v43, v134, v130, s27
    v_mfma_f32_16x16x32_bf16 v[60:63], v[32:35], v[44:47], v[60:63]
    v_perm_b32 v44, v110, v106, s28
    v_perm_b32 v45, v118, v114, s28
    v_perm_b32 v46, v126, v122, s28
    v_perm_b32 v47, v134, v130, s28
    v_mfma_f32_16x16x32_bf16 v[64:67], v[32:35], v[40:43], v[64:67]
    v_perm_b32 v40, v111, v107, s27
    v_perm_b32 v41, v119, v115, s27
    v_perm_b32 v42, v127, v123, s27
    v_perm_b32 v43, v135, v131, s27
    v_mfma_f32_16x16x32_bf16 v[68:71], v[32:35], v[44:47], v[68:71]
    v_perm_b32 v44, v111, v107, s28
    v_perm_b32 v45, v119, v115, s28
    v_perm_b32 v46, v127, v123, s28
    v_perm_b32 v47, v135, v131, s28
    v_mfma_f32_16x16x32_bf16 v[72:75], v[32:35], v[40:43], v[72:75]
    s_nop 1
    v_mfma_f32_16x16x32_bf16 v[76:79], v[32:35], v[44:47], v[76:79]
M_cds:
    s_cmp_eq_u32 s26, 0
    s_cselect_b32 s63, 256, 0
    s_add_u32 s25, s25, s63
    s_cmp_eq_u32 s25, 1024
    s_cbranch_scc0 M_its
    s_cmp_lg_u32 s31, 0
    s_cbranch_scc1 M_dofl
    s_sub_u32 s38, s22, 4
    s_mul_i32 s38, s38, 20480
    v_and_b32 v14, 63, v0
    v_lshl_add_u32 v14, v14, 4, s38
    v_add_u32 v14, 12288, v14
    global_load_dwordx4 v[104:107], v14, s[20:21] offset:0 sc1
    global_load_dwordx4 v[108:111], v14, s[20:21] offset:1024 sc1
    global_load_dwordx4 v[112:115], v14, s[20:21] offset:2048 sc1
    global_load_dwordx4 v[116:119], v14, s[20:21] offset:3072 sc1
    v_add_u32 v14, 4096, v14
    global_load_dwordx4 v[120:123], v14, s[20:21] offset:0 sc1
    global_load_dwordx4 v[124:127], v14, s[20:21] offset:1024 sc1
    global_load_dwordx4 v[128:131], v14, s[20:21] offset:2048 sc1
    global_load_dwordx4 v[132:135], v14, s[20:21] offset:3072 sc1
    s_branch M_dofl
M_flush:
    s_mov_b64 exec, s[58:59]
    s_cmp_eq_u32 s25, 512
    s_cbranch_scc1 M_fl1
    s_cmp_eq_u32 s25, 768
    s_cbranch_scc1 M_fl2
    s_cmp_eq_u32 s25, 1024
    s_cbranch_scc1 M_fl3
    s_nop 1
    s_or_b32 s32, s30, s31
    s_cmp_eq_u32 s32, 0
    s_cbranch_scc1 M_wc0
    s_mul_i32 s32, s3, 12
    s_add_u32 s32, s32, s22
    s_mul_i32 s32, s32, 22528
    s_add_u32 s32, s32, 16777216
    v_and_b32 v12, 63, v0
    v_lshl_add_u32 v12, v12, 2, s32
    s_waitcnt lgkmcnt(0)
    s_cmp_eq_u32 s30, 0
    s_cbranch_scc1 M_wd0
    global_load_dword v40, v12, s[68:69] offset:0 sc1
    global_load_dword v41, v12, s[68:69] offset:256 sc1
    global_load_dword v42, v12, s[68:69] offset:512 sc1
    global_load_dword v43, v12, s[68:69] offset:768 sc1
    global_load_dword v44, v12, s[68:69] offset:1024 sc1
    global_load_dword v45, v12, s[68:69] offset:1280 sc1
    global_load_dword v46, v12, s[68:69] offset:1536 sc1
    global_load_dword v47, v12, s[68:69] offset:1792 sc1
    s_waitcnt vmcnt(0)
    v_add_f32 v48, v48, v40
    v_add_f32 v52, v52, v41
    v_add_f32 v56, v56, v42
    v_add_f32 v60, v60, v43
    v_add_f32 v64, v64, v44
    v_add_f32 v68, v68, v45
    v_add_f32 v72, v72, v46
    v_add_f32 v76, v76, v47
M_wd0:
    global_store_dword v12, v48, s[68:69] offset:0 sc1
    global_store_dword v12, v52, s[68:69] offset:256 sc1
    global_store_dword v12, v56, s[68:69] offset:512 sc1
    global_store_dword v12, v60, s[68:69] offset:768 sc1
    global_store_dword v12, v64, s[68:69] offset:1024 sc1
    global_store_dword v12, v68, s[68:69] offset:1280 sc1
    global_store_dword v12, v72, s[68:69] offset:1536 sc1
    global_store_dword v12, v76, s[68:69] offset:1792 sc1
    s_waitcnt vmcnt(0)
M_wc0:
    v_cvt_pk_bf16_f32 v40, v48, v52
    v_cvt_pk_bf16_f32 v41, v56, v60
    v_cvt_pk_bf16_f32 v42, v64, v68
    v_cvt_pk_bf16_f32 v43, v72, v76
    ds_write_b128 v6, v[40:43] offset:0
    s_or_b32 s32, s30, s31
    s_cmp_eq_u32 s32, 0
    s_cbranch_scc1 M_wc1
    s_mul_i32 s32, s3, 12
    s_add_u32 s32, s32, s22
    s_mul_i32 s32, s32, 22528
    s_add_u32 s32, s32, 16781312
    v_and_b32 v12, 63, v0
    v_lshl_add_u32 v12, v12, 2, s32
    s_waitcnt lgkmcnt(0)
    s_cmp_eq_u32 s30, 0
    s_cbranch_scc1 M_wd1
    global_load_dword v40, v12, s[68:69] offset:0 sc1
    global_load_dword v41, v12, s[68:69] offset:256 sc1
    global_load_dword v42, v12, s[68:69] offset:512 sc1
    global_load_dword v43, v12, s[68:69] offset:768 sc1
    global_load_dword v44, v12, s[68:69] offset:1024 sc1
    global_load_dword v45, v12, s[68:69] offset:1280 sc1
    global_load_dword v46, v12, s[68:69] offset:1536 sc1
    global_load_dword v47, v12, s[68:69] offset:1792 sc1
    s_waitcnt vmcnt(0)
    v_add_f32 v49, v49, v40
    v_add_f32 v53, v53, v41
    v_add_f32 v57, v57, v42
    v_add_f32 v61, v61, v43
    v_add_f32 v65, v65, v44
    v_add_f32 v69, v69, v45
    v_add_f32 v73, v73, v46
    v_add_f32 v77, v77, v47
M_wd1:
    global_store_dword v12, v49, s[68:69] offset:0 sc1
    global_store_dword v12, v53, s[68:69] offset:256 sc1
    global_store_dword v12, v57, s[68:69] offset:512 sc1
    global_store_dword v12, v61, s[68:69] offset:768 sc1
    global_store_dword v12, v65, s[68:69] offset:1024 sc1
    global_store_dword v12, v69, s[68:69] offset:1280 sc1
    global_store_dword v12, v73, s[68:69] offset:1536 sc1
    global_store_dword v12, v77, s[68:69] offset:1792 sc1
    s_waitcnt vmcnt(0)
M_wc1:
    v_cvt_pk_bf16_f32 v44, v49, v53
    v_cvt_pk_bf16_f32 v45, v57, v61
    v_cvt_pk_bf16_f32 v46, v65, v69
    v_cvt_pk_bf16_f32 v47, v73, v77
    ds_write_b128 v6, v[44:47] offset:512
    s_or_b32 s32, s30, s31
    s_cmp_eq_u32 s32, 0
    s_cbranch_scc1 M_wc2
    s_mul_i32 s32, s3, 12
    s_add_u32 s32, s32, s22
    s_mul_i32 s32, s32, 22528
    s_add_u32 s32, s32, 16787456
    v_and_b32 v12, 63, v0
    v_lshl_add_u32 v12, v12, 2, s32
    s_waitcnt lgkmcnt(0)
    s_cmp_eq_u32 s30, 0
    s_cbranch_scc1 M_wd2
    global_load_dword v40, v12, s[68:69] offset:0 sc1
    global_load_dword v41, v12, s[68:69] offset:256 sc1
    global_load_dword v42, v12, s[68:69] offset:512 sc1
    global_load_dword v43, v12, s[68:69] offset:768 sc1
    global_load_dword v44, v12, s[68:69] offset:1024 sc1
    global_load_dword v45, v12, s[68:69] offset:1280 sc1
    global_load_dword v46, v12, s[68:69] offset:1536 sc1
    global_load_dword v47, v12, s[68:69] offset:1792 sc1
    s_waitcnt vmcnt(0)
    v_add_f32 v50, v50, v40
    v_add_f32 v54, v54, v41
    v_add_f32 v58, v58, v42
    v_add_f32 v62, v62, v43
    v_add_f32 v66, v66, v44
    v_add_f32 v70, v70, v45
    v_add_f32 v74, v74, v46
    v_add_f32 v78, v78, v47
M_wd2:
    global_store_dword v12, v50, s[68:69] offset:0 sc1
    global_store_dword v12, v54, s[68:69] offset:256 sc1
    global_store_dword v12, v58, s[68:69] offset:512 sc1
    global_store_dword v12, v62, s[68:69] offset:768 sc1
    global_store_dword v12, v66, s[68:69] offset:1024 sc1
    global_store_dword v12, v70, s[68:69] offset:1280 sc1
    global_store_dword v12, v74, s[68:69] offset:1536 sc1
    global_store_dword v12, v78, s[68:69] offset:1792 sc1
    s_waitcnt vmcnt(0)
M_wc2:
    v_cvt_pk_bf16_f32 v40, v50, v54
    v_cvt_pk_bf16_f32 v41, v58, v62
    v_cvt_pk_bf16_f32 v42, v66, v70
    v_cvt_pk_bf16_f32 v43, v74, v78
    s_cmp_ge_u32 s22, 4
    s_cselect_b32 s57, 0xffff, 0
    s_mov_b32 s56, 0
    v_xor_b32 v13, 128, v6
    v_cndmask_b32 v13, v6, v13, s[56:57]
    ds_write_b128 v13, v[40:43] offset:1280
    s_or_b32 s32, s30, s31
    s_cmp_eq_u32 s32, 0
    s_cbranch_scc1 M_wc3
    s_mul_i32 s32, s3, 12
    s_add_u32 s32, s32, s22
    s_mul_i32 s32, s32, 22528
    s_add_u32 s32, s32, 16793600
    v_and_b32 v12, 63, v0
    v_lshl_add_u32 v12, v12, 2, s32
    s_waitcnt lgkmcnt(0)
    s_cmp_eq_u32 s30, 0
    s_cbranch_scc1 M_wd3
    global_load_dword v40, v12, s[68:69] offset:0 sc1
    global_load_dword v41, v12, s[68:69] offset:256 sc1
    global_load_dword v42, v12, s[68:69] offset:512 sc1
    global_load_dword v43, v12, s[68:69] offset:768 sc1
    global_load_dword v44, v12, s[68:69] offset:1024 sc1
    global_load_dword v45, v12, s[68:69] offset:1280 sc1
    global_load_dword v46, v12, s[68:69] offset:1536 sc1
    global_load_dword v47, v12, s[68:69] offset:1792 sc1
    s_waitcnt vmcnt(0)
    v_add_f32 v51, v51, v40
    v_add_f32 v55, v55, v41
    v_add_f32 v59, v59, v42
    v_add_f32 v63, v63, v43
    v_add_f32 v67, v67, v44
    v_add_f32 v71, v71, v45
    v_add_f32 v75, v75, v46
    v_add_f32 v79, v79, v47
M_wd3:
    global_store_dword v12, v51, s[68:69] offset:0 sc1
    global_store_dword v12, v55, s[68:69] offset:256 sc1
    global_store_dword v12, v59, s[68:69] offset:512 sc1
    global_store_dword v12, v63, s[68:69] offset:768 sc1
    global_store_dword v12, v67, s[68:69] offset:1024 sc1
    global_store_dword v12, v71, s[68:69] offset:1280 sc1
    global_store_dword v12, v75, s[68:69] offset:1536 sc1
    global_store_dword v12, v79, s[68:69] offset:1792 sc1
    s_waitcnt vmcnt(0)
M_wc3:
    v_cvt_pk_bf16_f32 v44, v51, v55
    v_cvt_pk_bf16_f32 v45, v59, v63
    v_cvt_pk_bf16_f32 v46, v67, v71
    v_cvt_pk_bf16_f32 v47, v75, v79
    ds_write_b128 v6, v[44:47] offset:2048
    s_mov_b64 exec, 1
    v_mov_b32 v14, 2136
    v_mov_b32 v15, 1
    ds_add_u32 v14, v15
    s_mov_b64 exec, -1
    s_setprio 2
    s_mov_b64 exec, -1
    s_setpc_b64 s[60:61]
M_fl1:
    s_nop 4
    s_or_b32 s32, s30, s31
    s_cmp_eq_u32 s32, 0
    s_cbranch_scc1 M_wc4
    s_mul_i32 s32, s3, 12
    s_add_u32 s32, s32, s22
    s_mul_i32 s32, s32, 22528
    s_add_u32 s32, s32, 16783360
    v_and_b32 v12, 63, v0
    v_lshl_add_u32 v12, v12, 2, s32
    s_waitcnt lgkmcnt(0)
    s_cmp_eq_u32 s30, 0
    s_cbranch_scc1 M_wd4
    global_load_dword v40, v12, s[68:69] offset:0 sc1
    global_load_dword v41, v12, s[68:69] offset:256 sc1
    global_load_dword v42, v12, s[68:69] offset:512 sc1
    global_load_dword v43, v12, s[68:69] offset:768 sc1
    global_load_dword v44, v12, s[68:69] offset:1024 sc1
    global_load_dword v45, v12, s[68:69] offset:1280 sc1
    global_load_dword v46, v12, s[68:69] offset:1536 sc1
    global_load_dword v47, v12, s[68:69] offset:1792 sc1
    s_waitcnt vmcnt(0)
    v_add_f32 v48, v48, v40
    v_add_f32 v52, v52, v41
    v_add_f32 v56, v56, v42
    v_add_f32 v60, v60, v43
    v_add_f32 v64, v64, v44
    v_add_f32 v68, v68, v45
    v_add_f32 v72, v72, v46
    v_add_f32 v76, v76, v47
M_wd4:
    global_store_dword v12, v48, s[68:69] offset:0 sc1
    global_store_dword v12, v52, s[68:69] offset:256 sc1
    global_store_dword v12, v56, s[68:69] offset:512 sc1
    global_store_dword v12, v60, s[68:69] offset:768 sc1
    global_store_dword v12, v64, s[68:69] offset:1024 sc1
    global_store_dword v12, v68, s[68:69] offset:1280 sc1
    global_store_dword v12, v72, s[68:69] offset:1536 sc1
    global_store_dword v12, v76, s[68:69] offset:1792 sc1
    s_waitcnt vmcnt(0)
M_wc4:
    v_cvt_pk_bf16_f32 v40, v48, v52
    v_cvt_pk_bf16_f32 v41, v56, v60
    v_cvt_pk_bf16_f32 v42, v64, v68
    v_cvt_pk_bf16_f32 v43, v72, v76
    ds_write_b128 v6, v[40:43] offset:768
    v_mov_b32 v80, v49
    v_mov_b32 v81, v53
    v_mov_b32 v82, v57
    v_mov_b32 v83, v61
    v_mov_b32 v84, v65
    v_mov_b32 v85, v69
    v_mov_b32 v86, v73
    v_mov_b32 v87, v77
    v_mov_b32 v88, v50
    v_mov_b32 v89, v54
    v_mov_b32 v90, v58
    v_mov_b32 v91, v62
    v_mov_b32 v92, v66
    v_mov_b32 v93, v70
    v_mov_b32 v94, v74
    v_mov_b32 v95, v78
    v_mov_b32 v96, v51
    v_mov_b32 v97, v55
    v_mov_b32 v98, v59
    v_mov_b32 v99, v63
    v_mov_b32 v100, v67
    v_mov_b32 v101, v71
    v_mov_b32 v102, v75
    v_mov_b32 v103, v79
    s_setprio 1
    s_mov_b64 exec, -1
    s_setpc_b64 s[60:61]
M_fl2:
    s_nop 2
    s_or_b32 s32, s30, s31
    s_cmp_eq_u32 s32, 0
    s_cbranch_scc1 M_wc5
    s_mul_i32 s32, s3, 12
    s_add_u32 s32, s32, s22
    s_mul_i32 s32, s32, 22528
    s_add_u32 s32, s32, 16789504
    v_and_b32 v12, 63, v0
    v_lshl_add_u32 v12, v12, 2, s32
    s_waitcnt lgkmcnt(0)
    s_cmp_eq_u32 s30, 0
    s_cbranch_scc1 M_wd5
    global_load_dword v40, v12, s[68:69] offset:0 sc1
    global_load_dword v41, v12, s[68:69] offset:256 sc1
    global_load_dword v42, v12, s[68:69] offset:512 sc1
    global_load_dword v43, v12, s[68:69] offset:768 sc1
    global_load_dword v44, v12, s[68:69] offset:1024 sc1
    global_load_dword v45, v12, s[68:69] offset:1280 sc1
    global_load_dword v46, v12, s[68:69] offset:1536 sc1
    global_load_dword v47, v12, s[68:69] offset:1792 sc1
    s_waitcnt vmcnt(0)
    v_add_f32 v48, v48, v40
    v_add_f32 v52, v52, v41
    v_add_f32 v56, v56, v42
    v_add_f32 v60, v60, v43
    v_add_f32 v64, v64, v44
    v_add_f32 v68, v68, v45
    v_add_f32 v72, v72, v46
    v_add_f32 v76, v76, v47
M_wd5:
    global_store_dword v12, v48, s[68:69] offset:0 sc1
    global_store_dword v12, v52, s[68:69] offset:256 sc1
    global_store_dword v12, v56, s[68:69] offset:512 sc1
    global_store_dword v12, v60, s[68:69] offset:768 sc1
    global_store_dword v12, v64, s[68:69] offset:1024 sc1
    global_store_dword v12, v68, s[68:69] offset:1280 sc1
    global_store_dword v12, v72, s[68:69] offset:1536 sc1
    global_store_dword v12, v76, s[68:69] offset:1792 sc1
    s_waitcnt vmcnt(0)
M_wc5:
    v_cvt_pk_bf16_f32 v44, v48, v52
    v_cvt_pk_bf16_f32 v45, v56, v60
    v_cvt_pk_bf16_f32 v46, v64, v68
    v_cvt_pk_bf16_f32 v47, v72, v76
    s_cmp_ge_u32 s22, 4
    s_cselect_b32 s57, 0xffff, 0
    s_mov_b32 s56, 0
    v_xor_b32 v13, 128, v6
    v_cndmask_b32 v13, v6, v13, s[56:57]
    ds_write_b128 v13, v[44:47] offset:1536
    v_sub_f32 v49, v49, v88
    v_sub_f32 v53, v53, v89
    v_sub_f32 v57, v57, v90
    v_sub_f32 v61, v61, v91
    v_sub_f32 v65, v65, v92
    v_sub_f32 v69, v69, v93
    v_sub_f32 v73, v73, v94
    v_sub_f32 v77, v77, v95
    s_or_b32 s32, s30, s31
    s_cmp_eq_u32 s32, 0
    s_cbranch_scc1 M_wc6
    s_mul_i32 s32, s3, 12
    s_add_u32 s32, s32, s22
    s_mul_i32 s32, s32, 22528
    s_add_u32 s32, s32, 16797696
    v_and_b32 v12, 63, v0
    v_lshl_add_u32 v12, v12, 2, s32
    s_waitcnt lgkmcnt(0)
    s_cmp_eq_u32 s30, 0
    s_cbranch_scc1 M_wd6
    global_load_dword v40, v12, s[68:69] offset:0 sc1
    global_load_dword v41, v12, s[68:69] offset:256 sc1
    global_load_dword v42, v12, s[68:69] offset:512 sc1
    global_load_dword v43, v12, s[68:69] offset:768 sc1
    global_load_dword v44, v12, s[68:69] offset:1024 sc1
    global_load_dword v45, v12, s[68:69] offset:1280 sc1
    global_load_dword v46, v12, s[68:69] offset:1536 sc1
    global_load_dword v47, v12, s[68:69] offset:1792 sc1
    s_waitcnt vmcnt(0)
    v_add_f32 v49, v49, v40
    v_add_f32 v53, v53, v41
    v_add_f32 v57, v57, v42
    v_add_f32 v61, v61, v43
    v_add_f32 v65, v65, v44
    v_add_f32 v69, v69, v45
    v_add_f32 v73, v73, v46
    v_add_f32 v77, v77, v47
M_wd6:
    global_store_dword v12, v49, s[68:69] offset:0 sc1
    global_store_dword v12, v53, s[68:69] offset:256 sc1
    global_store_dword v12, v57, s[68:69] offset:512 sc1
    global_store_dword v12, v61, s[68:69] offset:768 sc1
    global_store_dword v12, v65, s[68:69] offset:1024 sc1
    global_store_dword v12, v69, s[68:69] offset:1280 sc1
    global_store_dword v12, v73, s[68:69] offset:1536 sc1
    global_store_dword v12, v77, s[68:69] offset:1792 sc1
    s_waitcnt vmcnt(0)
M_wc6:
    v_cvt_pk_bf16_f32 v40, v49, v53
    v_cvt_pk_bf16_f32 v41, v57, v61
    v_cvt_pk_bf16_f32 v42, v65, v69
    v_cvt_pk_bf16_f32 v43, v73, v77
    ds_write_b128 v6, v[40:43] offset:2560
    v_add_f32 v80, v80, v50
    v_add_f32 v81, v81, v54
    v_add_f32 v82, v82, v58
    v_add_f32 v83, v83, v62
    v_add_f32 v84, v84, v66
    v_add_f32 v85, v85, v70
    v_add_f32 v86, v86, v74
    v_add_f32 v87, v87, v78
    v_mov_b32 v88, v51
    v_mov_b32 v89, v55
    v_mov_b32 v90, v59
    v_mov_b32 v91, v63
    v_mov_b32 v92, v67
    v_mov_b32 v93, v71
    v_mov_b32 v94, v75
    v_mov_b32 v95, v79
    s_mov_b64 exec, 1
    v_mov_b32 v14, 2128
    v_mov_b32 v15, 1
    ds_add_u32 v14, v15
    s_setprio 0
    s_mov_b64 exec, -1
    s_setpc_b64 s[60:61]
M_fl3:
    s_or_b32 s32, s30, s31
    s_cmp_eq_u32 s32, 0
    s_cbranch_scc1 M_wc7
    s_mul_i32 s32, s3, 12
    s_add_u32 s32, s32, s22
    s_mul_i32 s32, s32, 22528
    s_add_u32 s32, s32, 16795648
    v_and_b32 v12, 63, v0
    v_lshl_add_u32 v12, v12, 2, s32
    s_waitcnt lgkmcnt(0)
    s_cmp_eq_u32 s30, 0
    s_cbranch_scc1 M_wd7
    global_load_dword v40, v12, s[68:69] offset:0 sc1
    global_load_dword v41, v12, s[68:69] offset:256 sc1
    global_load_dword v42, v12, s[68:69] offset:512 sc1
    global_load_dword v43, v12, s[68:69] offset:768 sc1
    global_load_dword v44, v12, s[68:69] offset:1024 sc1
    global_load_dword v45, v12, s[68:69] offset:1280 sc1
    global_load_dword v46, v12, s[68:69] offset:1536 sc1
    global_load_dword v47, v12, s[68:69] offset:1792 sc1
    s_waitcnt vmcnt(0)
    v_add_f32 v48, v48, v40
    v_add_f32 v52, v52, v41
    v_add_f32 v56, v56, v42
    v_add_f32 v60, v60, v43
    v_add_f32 v64, v64, v44
    v_add_f32 v68, v68, v45
    v_add_f32 v72, v72, v46
    v_add_f32 v76, v76, v47
M_wd7:
    global_store_dword v12, v48, s[68:69] offset:0 sc1
    global_store_dword v12, v52, s[68:69] offset:256 sc1
    global_store_dword v12, v56, s[68:69] offset:512 sc1
    global_store_dword v12, v60, s[68:69] offset:768 sc1
    global_store_dword v12, v64, s[68:69] offset:1024 sc1
    global_store_dword v12, v68, s[68:69] offset:1280 sc1
    global_store_dword v12, v72, s[68:69] offset:1536 sc1
    global_store_dword v12, v76, s[68:69] offset:1792 sc1
    s_waitcnt vmcnt(0)
M_wc7:
    v_cvt_pk_bf16_f32 v44, v48, v52
    v_cvt_pk_bf16_f32 v45, v56, v60
    v_cvt_pk_bf16_f32 v46, v64, v68
    v_cvt_pk_bf16_f32 v47, v72, v76
    ds_write_b128 v6, v[44:47] offset:2304
    v_sub_f32 v96, v96, v49
    v_sub_f32 v97, v97, v53
    v_sub_f32 v98, v98, v57
    v_sub_f32 v99, v99, v61
    v_sub_f32 v100, v100, v65
    v_sub_f32 v101, v101, v69
    v_sub_f32 v102, v102, v73
    v_sub_f32 v103, v103, v77
    s_or_b32 s32, s30, s31
    s_cmp_eq_u32 s32, 0
    s_cbranch_scc1 M_wc8
    s_mul_i32 s32, s3, 12
    s_add_u32 s32, s32, s22
    s_mul_i32 s32, s32, 22528
    s_add_u32 s32, s32, 16791552
    v_and_b32 v12, 63, v0
    v_lshl_add_u32 v12, v12, 2, s32
    s_waitcnt lgkmcnt(0)
    s_cmp_eq_u32 s30, 0
    s_cbranch_scc1 M_wd8
    global_load_dword v40, v12, s[68:69] offset:0 sc1
    global_load_dword v41, v12, s[68:69] offset:256 sc1
    global_load_dword v42, v12, s[68:69] offset:512 sc1
    global_load_dword v43, v12, s[68:69] offset:768 sc1
    global_load_dword v44, v12, s[68:69] offset:1024 sc1
    global_load_dword v45, v12, s[68:69] offset:1280 sc1
    global_load_dword v46, v12, s[68:69] offset:1536 sc1
    global_load_dword v47, v12, s[68:69] offset:1792 sc1
    s_waitcnt vmcnt(0)
    v_add_f32 v96, v96, v40
    v_add_f32 v97, v97, v41
    v_add_f32 v98, v98, v42
    v_add_f32 v99, v99, v43
    v_add_f32 v100, v100, v44
    v_add_f32 v101, v101, v45
    v_add_f32 v102, v102, v46
    v_add_f32 v103, v103, v47
M_wd8:
    global_store_dword v12, v96, s[68:69] offset:0 sc1
    global_store_dword v12, v97, s[68:69] offset:256 sc1
    global_store_dword v12, v98, s[68:69] offset:512 sc1
    global_store_dword v12, v99, s[68:69] offset:768 sc1
    global_store_dword v12, v100, s[68:69] offset:1024 sc1
    global_store_dword v12, v101, s[68:69] offset:1280 sc1
    global_store_dword v12, v102, s[68:69] offset:1536 sc1
    global_store_dword v12, v103, s[68:69] offset:1792 sc1
    s_waitcnt vmcnt(0)
M_wc8:
    v_cvt_pk_bf16_f32 v40, v96, v97
    v_cvt_pk_bf16_f32 v41, v98, v99
    v_cvt_pk_bf16_f32 v42, v100, v101
    v_cvt_pk_bf16_f32 v43, v102, v103
    s_cmp_ge_u32 s22, 4
    s_cselect_b32 s57, 0xffff, 0
    s_mov_b32 s56, 0
    v_xor_b32 v13, 128, v6
    v_cndmask_b32 v13, v6, v13, s[56:57]
    ds_write_b128 v13, v[40:43] offset:1792
    v_sub_f32 v50, v50, v88
    v_sub_f32 v54, v54, v89
    v_sub_f32 v58, v58, v90
    v_sub_f32 v62, v62, v91
    v_sub_f32 v66, v66, v92
    v_sub_f32 v70, v70, v93
    v_sub_f32 v74, v74, v94
    v_sub_f32 v78, v78, v95
    s_or_b32 s32, s30, s31
    s_cmp_eq_u32 s32, 0
    s_cbranch_scc1 M_wc9
    s_mul_i32 s32, s3, 12
    s_add_u32 s32, s32, s22
    s_mul_i32 s32, s32, 22528
    s_add_u32 s32, s32, 16785408
    v_and_b32 v12, 63, v0
    v_lshl_add_u32 v12, v12, 2, s32
    s_waitcnt lgkmcnt(0)
    s_cmp_eq_u32 s30, 0
    s_cbranch_scc1 M_wd9
    global_load_dword v40, v12, s[68:69] offset:0 sc1
    global_load_dword v41, v12, s[68:69] offset:256 sc1
    global_load_dword v42, v12, s[68:69] offset:512 sc1
    global_load_dword v43, v12, s[68:69] offset:768 sc1
    global_load_dword v44, v12, s[68:69] offset:1024 sc1
    global_load_dword v45, v12, s[68:69] offset:1280 sc1
    global_load_dword v46, v12, s[68:69] offset:1536 sc1
    global_load_dword v47, v12, s[68:69] offset:1792 sc1
    s_waitcnt vmcnt(0)
    v_add_f32 v50, v50, v40
    v_add_f32 v54, v54, v41
    v_add_f32 v58, v58, v42
    v_add_f32 v62, v62, v43
    v_add_f32 v66, v66, v44
    v_add_f32 v70, v70, v45
    v_add_f32 v74, v74, v46
    v_add_f32 v78, v78, v47
M_wd9:
    global_store_dword v12, v50, s[68:69] offset:0 sc1
    global_store_dword v12, v54, s[68:69] offset:256 sc1
    global_store_dword v12, v58, s[68:69] offset:512 sc1
    global_store_dword v12, v62, s[68:69] offset:768 sc1
    global_store_dword v12, v66, s[68:69] offset:1024 sc1
    global_store_dword v12, v70, s[68:69] offset:1280 sc1
    global_store_dword v12, v74, s[68:69] offset:1536 sc1
    global_store_dword v12, v78, s[68:69] offset:1792 sc1
    s_waitcnt vmcnt(0)
M_wc9:
    v_cvt_pk_bf16_f32 v44, v50, v54
    v_cvt_pk_bf16_f32 v45, v58, v62
    v_cvt_pk_bf16_f32 v46, v66, v70
    v_cvt_pk_bf16_f32 v47, v74, v78
    ds_write_b128 v6, v[44:47] offset:1024
    v_add_f32 v80, v80, v51
    v_add_f32 v81, v81, v55
    v_add_f32 v82, v82, v59
    v_add_f32 v83, v83, v63
    v_add_f32 v84, v84, v67
    v_add_f32 v85, v85, v71
    v_add_f32 v86, v86, v75
    v_add_f32 v87, v87, v79
    s_or_b32 s32, s30, s31
    s_cmp_eq_u32 s32, 0
    s_cbranch_scc1 M_wc10
    s_mul_i32 s32, s3, 12
    s_add_u32 s32, s32, s22
    s_mul_i32 s32, s32, 22528
    s_add_u32 s32, s32, 16779264
    v_and_b32 v12, 63, v0
    v_lshl_add_u32 v12, v12, 2, s32
    s_waitcnt lgkmcnt(0)
    s_cmp_eq_u32 s30, 0
    s_cbranch_scc1 M_wd10
    global_load_dword v40, v12, s[68:69] offset:0 sc1
    global_load_dword v41, v12, s[68:69] offset:256 sc1
    global_load_dword v42, v12, s[68:69] offset:512 sc1
    global_load_dword v43, v12, s[68:69] offset:768 sc1
    global_load_dword v44, v12, s[68:69] offset:1024 sc1
    global_load_dword v45, v12, s[68:69] offset:1280 sc1
    global_load_dword v46, v12, s[68:69] offset:1536 sc1
    global_load_dword v47, v12, s[68:69] offset:1792 sc1
    s_waitcnt vmcnt(0)
    v_add_f32 v80, v80, v40
    v_add_f32 v81, v81, v41
    v_add_f32 v82, v82, v42
    v_add_f32 v83, v83, v43
    v_add_f32 v84, v84, v44
    v_add_f32 v85, v85, v45
    v_add_f32 v86, v86, v46
    v_add_f32 v87, v87, v47
M_wd10:
    global_store_dword v12, v80, s[68:69] offset:0 sc1
    global_store_dword v12, v81, s[68:69] offset:256 sc1
    global_store_dword v12, v82, s[68:69] offset:512 sc1
    global_store_dword v12, v83, s[68:69] offset:768 sc1
    global_store_dword v12, v84, s[68:69] offset:1024 sc1
    global_store_dword v12, v85, s[68:69] offset:1280 sc1
    global_store_dword v12, v86, s[68:69] offset:1536 sc1
    global_store_dword v12, v87, s[68:69] offset:1792 sc1
    s_waitcnt vmcnt(0)
M_wc10:
    v_cvt_pk_bf16_f32 v40, v80, v81
    v_cvt_pk_bf16_f32 v41, v82, v83
    v_cvt_pk_bf16_f32 v42, v84, v85
    v_cvt_pk_bf16_f32 v43, v86, v87
    ds_write_b128 v6, v[40:43] offset:256
    s_cmp_lt_u32 s22, 4
    s_cbranch_scc1 M_fl3b
    s_mov_b64 exec, 1
    v_mov_b32 v14, 2132
    v_mov_b32 v15, 1
    ds_add_u32 v14, v15
M_fl3b:
    s_mov_b64 exec, -1
    s_setpc_b64 s[60:61]
M_end:
    s_cmp_eq_u32 s31, 0
    s_cbranch_scc1 M_gemm
    s_mov_b32 s30, 1
    s_waitcnt lgkmcnt(0)
    s_barrier
    s_branch M_init
M_gemm:
    s_setprio 0
    s_waitcnt lgkmcnt(0)
    v_and_b32 v16, 63, v0
    s_cmp_ge_u32 s22, 4
    s_cbranch_scc1 M_gw
    v_lshlrev_b32 v16, 4, v16
    s_add_u32 s35, s22, 16
    s_sub_u32 s32, s35, 16
    s_lshr_b32 s33, s32, 3
    s_and_b32 s32, s32, 7
    s_add_u32 s32, s32, 4
    s_mul_i32 s33, s33, 12
    s_add_u32 s32, s32, s33
    s_lshl_b32 s32, s32, 18
    s_lshl_b32 s33, s3, 10
    s_add_u32 s32, s32, s33
    v_add_u32 v40, s32, v16
    s_add_u32 s35, s22, 20
    s_sub_u32 s32, s35, 16
    s_lshr_b32 s33, s32, 3
    s_and_b32 s32, s32, 7
    s_add_u32 s32, s32, 4
    s_mul_i32 s33, s33, 12
    s_add_u32 s32, s32, s33
    s_lshl_b32 s32, s32, 18
    s_lshl_b32 s33, s3, 10
    s_add_u32 s32, s32, s33
    v_add_u32 v41, s32, v16
    s_add_u32 s35, s22, 24
    s_sub_u32 s32, s35, 16
    s_lshr_b32 s33, s32, 3
    s_and_b32 s32, s32, 7
    s_add_u32 s32, s32, 4
    s_mul_i32 s33, s33, 12
    s_add_u32 s32, s32, s33
    s_lshl_b32 s32, s32, 18
    s_lshl_b32 s33, s3, 10
    s_add_u32 s32, s32, s33
    v_add_u32 v42, s32, v16
    s_add_u32 s35, s22, 28
    s_sub_u32 s32, s35, 16
    s_lshr_b32 s33, s32, 3
    s_and_b32 s32, s32, 7
    s_add_u32 s32, s32, 4
    s_mul_i32 s33, s33, 12
    s_add_u32 s32, s32, s33
    s_lshl_b32 s32, s32, 18
    s_lshl_b32 s33, s3, 10
    s_add_u32 s32, s32, s33
    v_add_u32 v43, s32, v16
    s_add_u32 s35, s22, 32
    s_sub_u32 s32, s35, 16
    s_lshr_b32 s33, s32, 3
    s_and_b32 s32, s32, 7
    s_add_u32 s32, s32, 4
    s_mul_i32 s33, s33, 12
    s_add_u32 s32, s32, s33
    s_lshl_b32 s32, s32, 18
    s_lshl_b32 s33, s3, 10
    s_add_u32 s32, s32, s33
    v_add_u32 v44, s32, v16
    s_add_u32 s35, s22, 36
    s_sub_u32 s32, s35, 16
    s_lshr_b32 s33, s32, 3
    s_and_b32 s32, s32, 7
    s_add_u32 s32, s32, 4
    s_mul_i32 s33, s33, 12
    s_add_u32 s32, s32, s33
    s_lshl_b32 s32, s32, 18
    s_lshl_b32 s33, s3, 10
    s_add_u32 s32, s32, s33
    v_add_u32 v45, s32, v16
    s_mul_i32 s32, s22, 1040
    s_add_u32 s32, s32, 131584
    v_add_u32 v18, s32, v16
    s_waitcnt lgkmcnt(0)
    s_barrier
    ds_read_b128 v[48:51], v18 offset:0
    ds_read_b128 v[52:55], v18 offset:4160
    ds_read_b128 v[56:59], v18 offset:8320
    ds_read_b128 v[60:63], v18 offset:12480
    ds_read_b128 v[64:67], v18 offset:16640
    ds_read_b128 v[68:71], v18 offset:20800
    s_waitcnt lgkmcnt(5)
    buffer_store_dwordx4 v[48:51], v40, s[8:11], 0 offen sc1
    s_waitcnt lgkmcnt(4)
    buffer_store_dwordx4 v[52:55], v41, s[8:11], 0 offen sc1
    s_waitcnt lgkmcnt(3)
    buffer_store_dwordx4 v[56:59], v42, s[8:11], 0 offen sc1
    s_waitcnt lgkmcnt(2)
    buffer_store_dwordx4 v[60:63], v43, s[8:11], 0 offen sc1
    s_waitcnt lgkmcnt(1)
    buffer_store_dwordx4 v[64:67], v44, s[8:11], 0 offen sc1
    s_waitcnt lgkmcnt(0)
    buffer_store_dwordx4 v[68:71], v45, s[8:11], 0 offen sc1
    s_branch M_st
M_gw:
    s_waitcnt lgkmcnt(0)
    s_sub_u32 s38, s22, 4
    s_mul_i32 s38, s38, 20480
    v_and_b32 v18, 63, v0
    v_lshl_add_u32 v18, v18, 4, s38
    v_add_u32 v18, 4096, v18
    global_load_dwordx4 v[88:91], v18, s[20:21] offset:0 sc1
    global_load_dwordx4 v[92:95], v18, s[20:21] offset:1024 sc1
    global_load_dwordx4 v[96:99], v18, s[20:21] offset:2048 sc1
    global_load_dwordx4 v[100:103], v18, s[20:21] offset:3072 sc1
    v_mov_b32 v14, 2128
    ds_read_b32 v15, v14
    v_and_b32 v12, 15, v16
    v_lshrrev_b32 v13, 4, v16
    v_mul_u32_u24 v17, 2816, v12
    v_xor_b32 v1, v13, v12
    v_lshl_add_u32 v1, v1, 4, v17
    v_add_u32 v1, 2304, v1
    v_xor_b32 v2, 64, v1
    v_xor_b32 v3, 128, v1
    v_xor_b32 v4, 192, v1
    v_add_u32 v76, 90112, v1
    v_add_u32 v77, 90112, v2
    v_add_u32 v78, 90112, v3
    v_add_u32 v79, 90112, v4
    v_lshrrev_b32 v0, 3, v12
    v_mul_i32_i24 v83, -21760, v0
    v_add_u32 v80, v76, v83
    v_add_u32 v81, v77, v83
    v_add_u32 v82, v78, v83
    v_add_u32 v83, v79, v83
    s_lshl_b32 s33, s22, 5
    s_add_u32 s33, s33, 114816
    v_mul_u32_u24 v17, 1040, v12
    v_lshl_add_u32 v17, v13, 3, v17
    v_add_u32 v17, s33, v17
    v_mul_i32_i24 v0, -8064, v0
    v_add_u32 v0, v0, v17
    s_mov_b32 s34, 0xbfb8aa3b
    v_lshlrev_b32 v16, 4, v16
M_fcwa:
    s_waitcnt lgkmcnt(0)
    v_readfirstlane_b32 s32, v15
    s_cmp_ge_u32 s32, 12
    s_cbranch_scc1 M_fcoka
    s_sleep 1
    ds_read_b32 v15, v14 offset:0
    s_sub_u32 s50, s50, 1
    s_cmp_gt_i32 s50, 0
    s_cbranch_scc1 M_fcwa
    s_waitcnt lgkmcnt(0)
M_fcoka:
    ds_read_b128 v[40:43], v1 offset:768
    ds_read_b128 v[44:47], v1 offset:1536
    ds_read_b128 v[48:51], v1 offset:45824
    ds_read_b128 v[52:55], v1 offset:46592
    ds_read_b128 v[56:59], v80 offset:768
    ds_read_b128 v[60:63], v2 offset:768
    s_waitcnt vmcnt(11) lgkmcnt(5)
    v_mfma_f32_16x16x32_bf16 v[136:139], v[104:107], v[40:43], v[136:139]
    ds_read_b128 v[40:43], v2 offset:1536
    s_waitcnt lgkmcnt(5)
    v_mfma_f32_16x16x32_bf16 v[140:143], v[104:107], v[44:47], v[140:143]
    ds_read_b128 v[44:47], v2 offset:45824
    s_waitcnt lgkmcnt(5)
    v_mfma_f32_16x16x32_bf16 v[148:151], v[104:107], v[48:51], v[148:151]
    ds_read_b128 v[48:51], v2 offset:46592
    s_waitcnt lgkmcnt(5)
    v_mfma_f32_16x16x32_bf16 v[152:155], v[104:107], v[52:55], v[152:155]
    ds_read_b128 v[52:55], v81 offset:768
    s_waitcnt lgkmcnt(5)
    v_mfma_f32_16x16x32_bf16 v[160:163], v[104:107], v[56:59], v[160:163]
    ds_read_b128 v[56:59], v3 offset:768
    s_waitcnt vmcnt(10) lgkmcnt(5)
    v_mfma_f32_16x16x32_bf16 v[136:139], v[108:111], v[60:63], v[136:139]
    ds_read_b128 v[60:63], v3 offset:1536
    s_waitcnt lgkmcnt(5)
    v_mfma_f32_16x16x32_bf16 v[140:143], v[108:111], v[40:43], v[140:143]
    ds_read_b128 v[40:43], v3 offset:45824
    s_waitcnt lgkmcnt(5)
    v_mfma_f32_16x16x32_bf16 v[148:151], v[108:111], v[44:47], v[148:151]
    ds_read_b128 v[44:47], v3 offset:46592
    s_waitcnt lgkmcnt(5)
    v_mfma_f32_16x16x32_bf16 v[152:155], v[108:111], v[48:51], v[152:155]
    ds_read_b128 v[48:51], v82 offset:768
    s_waitcnt lgkmcnt(5)
    v_mfma_f32_16x16x32_bf16 v[160:163], v[108:111], v[52:55], v[160:163]
    ds_read_b128 v[52:55], v4 offset:768
    s_waitcnt vmcnt(9) lgkmcnt(5)
    v_mfma_f32_16x16x32_bf16 v[136:139], v[112:115], v[56:59], v[136:139]
    ds_read_b128 v[56:59], v4 offset:1536
    s_waitcnt lgkmcnt(5)
    v_mfma_f32_16x16x32_bf16 v[140:143], v[112:115], v[60:63], v[140:143]
    ds_read_b128 v[60:63], v4 offset:45824
    s_waitcnt lgkmcnt(5)
    v_mfma_f32_16x16x32_bf16 v[148:151], v[112:115], v[40:43], v[148:151]
    ds_read_b128 v[40:43], v4 offset:46592
    s_waitcnt lgkmcnt(5)
    v_mfma_f32_16x16x32_bf16 v[152:155], v[112:115], v[44:47], v[152:155]
    ds_read_b128 v[44:47], v83 offset:768
    s_waitcnt lgkmcnt(5)
    v_mfma_f32_16x16x32_bf16 v[160:163], v[112:115], v[48:51], v[160:163]
    ds_read_b128 v[48:51], v1 offset:2560
    s_waitcnt vmcnt(8) lgkmcnt(5)
    v_mfma_f32_16x16x32_bf16 v[136:139], v[116:119], v[52:55], v[136:139]
    ds_read_b128 v[52:55], v1 offset:47616
    s_waitcnt lgkmcnt(5)
    v_mfma_f32_16x16x32_bf16 v[140:143], v[116:119], v[56:59], v[140:143]
    ds_read_b128 v[56:59], v76 offset:2560
    s_waitcnt lgkmcnt(5)
    v_mfma_f32_16x16x32_bf16 v[148:151], v[116:119], v[60:63], v[148:151]
    ds_read_b128 v[60:63], v2 offset:2560
    s_waitcnt lgkmcnt(5)
    v_mfma_f32_16x16x32_bf16 v[152:155], v[116:119], v[40:43], v[152:155]
    ds_read_b128 v[40:43], v2 offset:47616
    s_waitcnt lgkmcnt(5)
    v_mfma_f32_16x16x32_bf16 v[160:163], v[116:119], v[44:47], v[160:163]
    ds_read_b128 v[44:47], v77 offset:2560
    s_waitcnt vmcnt(7) lgkmcnt(5)
    v_mfma_f32_16x16x32_bf16 v[144:147], v[120:123], v[48:51], v[144:147]
    ds_read_b128 v[48:51], v3 offset:2560
    s_waitcnt lgkmcnt(5)
    v_mfma_f32_16x16x32_bf16 v[156:159], v[120:123], v[52:55], v[156:159]
    ds_read_b128 v[52:55], v3 offset:47616
    s_waitcnt lgkmcnt(5)
    v_mfma_f32_16x16x32_bf16 v[164:167], v[120:123], v[56:59], v[164:167]
    ds_read_b128 v[56:59], v78 offset:2560
    s_waitcnt vmcnt(6) lgkmcnt(5)
    v_mfma_f32_16x16x32_bf16 v[144:147], v[124:127], v[60:63], v[144:147]
    ds_read_b128 v[60:63], v4 offset:2560
    s_waitcnt lgkmcnt(5)
    v_mfma_f32_16x16x32_bf16 v[156:159], v[124:127], v[40:43], v[156:159]
    ds_read_b128 v[40:43], v4 offset:47616
    s_waitcnt lgkmcnt(5)
    v_mfma_f32_16x16x32_bf16 v[164:167], v[124:127], v[44:47], v[164:167]
    ds_read_b128 v[44:47], v79 offset:2560
    s_waitcnt vmcnt(5) lgkmcnt(5)
    v_mfma_f32_16x16x32_bf16 v[144:147], v[128:131], v[48:51], v[144:147]
    s_waitcnt lgkmcnt(4)
    v_mfma_f32_16x16x32_bf16 v[156:159], v[128:131], v[52:55], v[156:159]
    s_waitcnt lgkmcnt(3)
    v_mfma_f32_16x16x32_bf16 v[164:167], v[128:131], v[56:59], v[164:167]
    ds_read_b32 v15, v14 offset:4
    s_waitcnt vmcnt(4) lgkmcnt(3)
    v_mfma_f32_16x16x32_bf16 v[144:147], v[132:135], v[60:63], v[144:147]
    s_waitcnt lgkmcnt(2)
    v_mfma_f32_16x16x32_bf16 v[156:159], v[132:135], v[40:43], v[156:159]
    s_waitcnt lgkmcnt(1)
    v_mfma_f32_16x16x32_bf16 v[164:167], v[132:135], v[44:47], v[164:167]
    s_setprio 0
M_fcwb:
    s_waitcnt lgkmcnt(0)
    v_readfirstlane_b32 s32, v15
    s_cmp_ge_u32 s32, 8
    s_cbranch_scc1 M_fcokb
    s_sleep 1
    ds_read_b32 v15, v14 offset:4
    s_sub_u32 s50, s50, 1
    s_cmp_gt_i32 s50, 0
    s_cbranch_scc1 M_fcwb
    s_waitcnt lgkmcnt(0)
M_fcokb:
    ds_read_b128 v[40:43], v1 offset:45312
    ds_read_b128 v[44:47], v76 offset:256
    ds_read_b128 v[48:51], v2 offset:45312
    ds_read_b128 v[52:55], v77 offset:256
    ds_read_b128 v[56:59], v3 offset:45312
    ds_read_b128 v[60:63], v78 offset:256
    s_waitcnt vmcnt(3) lgkmcnt(5)
    v_mfma_f32_16x16x32_bf16 v[20:23], v[88:91], v[40:43], v[20:23]
    ds_read_b128 v[40:43], v4 offset:45312
    s_waitcnt lgkmcnt(5)
    v_mfma_f32_16x16x32_bf16 v[36:39], v[88:91], v[44:47], v[36:39]
    ds_read_b128 v[44:47], v79 offset:256
    s_waitcnt vmcnt(2) lgkmcnt(5)
    v_mfma_f32_16x16x32_bf16 v[20:23], v[92:95], v[48:51], v[20:23]
    ds_read_b128 v[48:51], v1 offset:47360
    s_waitcnt lgkmcnt(5)
    v_mfma_f32_16x16x32_bf16 v[36:39], v[92:95], v[52:55], v[36:39]
    ds_read_b128 v[52:55], v1 offset:46080
    s_waitcnt vmcnt(1) lgkmcnt(5)
    v_mfma_f32_16x16x32_bf16 v[20:23], v[96:99], v[56:59], v[20:23]
    ds_read_b128 v[56:59], v1 offset:46848
    s_waitcnt lgkmcnt(5)
    v_mfma_f32_16x16x32_bf16 v[36:39], v[96:99], v[60:63], v[36:39]
    ds_read_b128 v[60:63], v2 offset:47360
    s_waitcnt vmcnt(0) lgkmcnt(5)
    v_mfma_f32_16x16x32_bf16 v[20:23], v[100:103], v[40:43], v[20:23]
    ds_read_b128 v[40:43], v2 offset:46080
    s_waitcnt lgkmcnt(5)
    v_mfma_f32_16x16x32_bf16 v[36:39], v[100:103], v[44:47], v[36:39]
    ds_read_b128 v[44:47], v2 offset:46848
    s_waitcnt lgkmcnt(5)
    v_mfma_f32_16x16x32_bf16 v[156:159], v[104:107], v[48:51], v[156:159]
    ds_read_b128 v[48:51], v3 offset:47360
    s_waitcnt lgkmcnt(5)
    v_mfma_f32_16x16x32_bf16 v[148:151], v[120:123], v[52:55], v[148:151]
    ds_read_b128 v[52:55], v3 offset:46080
    s_waitcnt lgkmcnt(5)
    v_mfma_f32_16x16x32_bf16 v[152:155], v[120:123], v[56:59], v[152:155]
    ds_read_b128 v[56:59], v3 offset:46848
    s_waitcnt lgkmcnt(5)
    v_mfma_f32_16x16x32_bf16 v[156:159], v[108:111], v[60:63], v[156:159]
    v_mul_f32 v68, s34, v20
    v_mul_f32 v69, s34, v21
    v_mul_f32 v70, s34, v22
    v_mul_f32 v71, s34, v23
    ds_read_b128 v[60:63], v4 offset:47360
    s_waitcnt lgkmcnt(5)
    v_mfma_f32_16x16x32_bf16 v[148:151], v[124:127], v[40:43], v[148:151]
    v_exp_f32 v68, v68
    v_exp_f32 v69, v69
    v_exp_f32 v70, v70
    v_exp_f32 v71, v71
    ds_read_b128 v[40:43], v4 offset:46080
    s_waitcnt lgkmcnt(5)
    v_mfma_f32_16x16x32_bf16 v[152:155], v[124:127], v[44:47], v[152:155]
    v_cvt_pk_bf16_f32 v20, v20, v21
    v_cvt_pk_bf16_f32 v21, v22, v23
    ds_write_b64 v17, v[20:21] offset:16640
    ds_read_b128 v[44:47], v4 offset:46848
    s_waitcnt lgkmcnt(6)
    v_mfma_f32_16x16x32_bf16 v[156:159], v[112:115], v[48:51], v[156:159]
    v_add_f32 v68, 1.0, v68
    v_add_f32 v69, 1.0, v69
    v_add_f32 v70, 1.0, v70
    v_add_f32 v71, 1.0, v71
    ds_read_b128 v[48:51], v76 offset:2304
    s_waitcnt lgkmcnt(6)
    v_mfma_f32_16x16x32_bf16 v[148:151], v[128:131], v[52:55], v[148:151]
    v_rcp_f32 v68, v68
    v_rcp_f32 v69, v69
    v_rcp_f32 v70, v70
    ds_read_b128 v[52:55], v80 offset:1024
    s_waitcnt lgkmcnt(6)
    v_mfma_f32_16x16x32_bf16 v[152:155], v[128:131], v[56:59], v[152:155]
    v_rcp_f32 v71, v71
    v_mul_f32 v72, s34, v36
    v_mul_f32 v73, s34, v37
    v_mul_f32 v74, s34, v38
    ds_read_b128 v[56:59], v77 offset:2304
    s_waitcnt lgkmcnt(6)
    v_mfma_f32_16x16x32_bf16 v[156:159], v[116:119], v[60:63], v[156:159]
    v_mul_f32 v75, s34, v39
    v_exp_f32 v72, v72
    v_exp_f32 v73, v73
    v_exp_f32 v74, v74
    ds_read_b128 v[60:63], v81 offset:1024
    s_waitcnt lgkmcnt(6)
    v_mfma_f32_16x16x32_bf16 v[148:151], v[132:135], v[40:43], v[148:151]
    v_exp_f32 v75, v75
    v_cvt_pk_bf16_f32 v36, v36, v37
    v_cvt_pk_bf16_f32 v37, v38, v39
    ds_read_b128 v[40:43], v78 offset:2304
    s_waitcnt lgkmcnt(5)
    v_mfma_f32_16x16x32_bf16 v[152:155], v[132:135], v[44:47], v[152:155]
    ds_write_b64 v17, v[36:37] offset:33280
    v_add_f32 v72, 1.0, v72
    v_add_f32 v73, 1.0, v73
    v_add_f32 v74, 1.0, v74
    ds_read_b128 v[44:47], v82 offset:1024
    s_waitcnt lgkmcnt(6)
    v_mfma_f32_16x16x32_bf16 v[164:167], v[104:107], v[48:51], v[164:167]
    v_add_f32 v75, 1.0, v75
    v_rcp_f32 v72, v72
    v_rcp_f32 v73, v73
    ds_read_b128 v[48:51], v79 offset:2304
    s_waitcnt lgkmcnt(6)
    v_mfma_f32_16x16x32_bf16 v[160:163], v[120:123], v[52:55], v[160:163]
    v_rcp_f32 v74, v74
    v_rcp_f32 v75, v75
    s_nop 1
    v_mov_b32_dpp v72, v72 row_shr:8 row_mask:0xf bank_mask:0xc
    ds_read_b128 v[52:55], v83 offset:1024
    s_waitcnt lgkmcnt(6)
    v_mfma_f32_16x16x32_bf16 v[164:167], v[108:111], v[56:59], v[164:167]
    v_mov_b32_dpp v73, v73 row_shr:8 row_mask:0xf bank_mask:0xc
    v_mov_b32_dpp v74, v74 row_shr:8 row_mask:0xf bank_mask:0xc
    v_mov_b32_dpp v75, v75 row_shr:8 row_mask:0xf bank_mask:0xc
    s_waitcnt lgkmcnt(5)
    v_mfma_f32_16x16x32_bf16 v[160:163], v[124:127], v[60:63], v[160:163]
    v_pk_mul_f32 v[156:157], v[156:157], v[68:69]
    v_pk_mul_f32 v[158:159], v[158:159], v[70:71]
    v_cvt_pk_bf16_f32 v156, v156, v157
    v_cvt_pk_bf16_f32 v157, v158, v159
    s_waitcnt lgkmcnt(4)
    v_mfma_f32_16x16x32_bf16 v[164:167], v[112:115], v[40:43], v[164:167]
    ds_write_b64 v17, v[156:157] offset:17408
    v_pk_mul_f32 v[148:149], v[148:149], v[68:69]
    v_pk_mul_f32 v[150:151], v[150:151], v[70:71]
    v_cvt_pk_bf16_f32 v148, v148, v149
    s_waitcnt lgkmcnt(3)
    v_mfma_f32_16x16x32_bf16 v[160:163], v[128:131], v[44:47], v[160:163]
    v_cvt_pk_bf16_f32 v149, v150, v151
    ds_write_b64 v17, v[148:149] offset:16896
    v_pk_mul_f32 v[152:153], v[152:153], v[68:69]
    v_pk_mul_f32 v[154:155], v[154:155], v[70:71]
    s_waitcnt lgkmcnt(3)
    v_mfma_f32_16x16x32_bf16 v[164:167], v[116:119], v[48:51], v[164:167]
    v_cvt_pk_bf16_f32 v152, v152, v153
    v_cvt_pk_bf16_f32 v153, v154, v155
    ds_write_b64 v17, v[152:153] offset:17152
    s_waitcnt lgkmcnt(3)
    v_mfma_f32_16x16x32_bf16 v[160:163], v[132:135], v[52:55], v[160:163]
    s_nop 5
    v_pk_mul_f32 v[164:165], v[164:165], v[72:73]
    v_pk_mul_f32 v[166:167], v[166:167], v[74:75]
    v_cvt_pk_bf16_f32 v164, v164, v165
    v_cvt_pk_bf16_f32 v165, v166, v167
    ds_write_b64 v17, v[164:165] offset:34048
    v_pk_mul_f32 v[160:161], v[160:161], v[72:73]
    v_pk_mul_f32 v[162:163], v[162:163], v[74:75]
    v_cvt_pk_bf16_f32 v160, v160, v161
    v_cvt_pk_bf16_f32 v161, v162, v163
    ds_write_b64 v0, v[160:161] offset:33536
    s_waitcnt lgkmcnt(0)
    s_barrier
    ds_read_b128 v[40:43], v1 offset:256
    ds_read_b128 v[44:47], v2 offset:256
    ds_read_b128 v[48:51], v3 offset:256
    ds_read_b128 v[52:55], v4 offset:256
    ds_read_b128 v[56:59], v1 offset:2304
    ds_read_b128 v[60:63], v1 offset:1024
    s_waitcnt lgkmcnt(5)
    v_mfma_f32_16x16x32_bf16 v[8:11], v[88:91], v[40:43], v[8:11]
    ds_read_b128 v[40:43], v1 offset:1792
    s_waitcnt lgkmcnt(5)
    v_mfma_f32_16x16x32_bf16 v[8:11], v[92:95], v[44:47], v[8:11]
    ds_read_b128 v[44:47], v2 offset:2304
    s_waitcnt lgkmcnt(5)
    v_mfma_f32_16x16x32_bf16 v[8:11], v[96:99], v[48:51], v[8:11]
    ds_read_b128 v[48:51], v2 offset:1024
    s_waitcnt lgkmcnt(5)
    v_mfma_f32_16x16x32_bf16 v[8:11], v[100:103], v[52:55], v[8:11]
    ds_read_b128 v[52:55], v2 offset:1792
    s_waitcnt lgkmcnt(5)
    v_mfma_f32_16x16x32_bf16 v[144:147], v[104:107], v[56:59], v[144:147]
    ds_read_b128 v[56:59], v3 offset:2304
    s_waitcnt lgkmcnt(5)
    v_mfma_f32_16x16x32_bf16 v[136:139], v[120:123], v[60:63], v[136:139]
    ds_read_b128 v[60:63], v3 offset:1024
    s_waitcnt lgkmcnt(5)
    v_mfma_f32_16x16x32_bf16 v[140:143], v[120:123], v[40:43], v[140:143]
    ds_read_b128 v[40:43], v3 offset:1792
    s_waitcnt lgkmcnt(5)
    v_mfma_f32_16x16x32_bf16 v[144:147], v[108:111], v[44:47], v[144:147]
    v_mul_f32 v64, s34, v8
    v_mul_f32 v65, s34, v9
    v_mul_f32 v66, s34, v10
    ds_read_b128 v[44:47], v4 offset:2304
    s_waitcnt lgkmcnt(5)
    v_mfma_f32_16x16x32_bf16 v[136:139], v[124:127], v[48:51], v[136:139]
    v_mul_f32 v67, s34, v11
    v_exp_f32 v64, v64
    ds_read_b128 v[48:51], v4 offset:1024
    s_waitcnt lgkmcnt(5)
    v_mfma_f32_16x16x32_bf16 v[140:143], v[124:127], v[52:55], v[140:143]
    v_exp_f32 v65, v65
    v_exp_f32 v66, v66
    v_exp_f32 v67, v67
    ds_read_b128 v[52:55], v4 offset:1792
    s_waitcnt lgkmcnt(5)
    v_mfma_f32_16x16x32_bf16 v[144:147], v[112:115], v[56:59], v[144:147]
    v_cvt_pk_bf16_f32 v8, v8, v9
    v_cvt_pk_bf16_f32 v9, v10, v11
    s_waitcnt lgkmcnt(4)
    v_mfma_f32_16x16x32_bf16 v[136:139], v[128:131], v[60:63], v[136:139]
    ds_write_b64 v17, v[8:9] offset:0
    v_add_f32 v64, 1.0, v64
    s_waitcnt lgkmcnt(4)
    v_mfma_f32_16x16x32_bf16 v[140:143], v[128:131], v[40:43], v[140:143]
    v_add_f32 v65, 1.0, v65
    v_add_f32 v66, 1.0, v66
    v_add_f32 v67, 1.0, v67
    s_waitcnt lgkmcnt(3)
    v_mfma_f32_16x16x32_bf16 v[144:147], v[116:119], v[44:47], v[144:147]
    v_rcp_f32 v64, v64
    v_rcp_f32 v65, v65
    s_waitcnt lgkmcnt(2)
    v_mfma_f32_16x16x32_bf16 v[136:139], v[132:135], v[48:51], v[136:139]
    v_rcp_f32 v66, v66
    v_rcp_f32 v67, v67
    s_waitcnt lgkmcnt(1)
    v_mfma_f32_16x16x32_bf16 v[140:143], v[132:135], v[52:55], v[140:143]
    s_nop 5
    v_pk_mul_f32 v[144:145], v[144:145], v[64:65]
    v_pk_mul_f32 v[146:147], v[146:147], v[66:67]
    v_cvt_pk_bf16_f32 v144, v144, v145
    v_cvt_pk_bf16_f32 v145, v146, v147
    ds_write_b64 v17, v[144:145] offset:768
    v_pk_mul_f32 v[136:137], v[136:137], v[64:65]
    v_pk_mul_f32 v[138:139], v[138:139], v[66:67]
    v_cvt_pk_bf16_f32 v136, v136, v137
    v_cvt_pk_bf16_f32 v137, v138, v139
    ds_write_b64 v17, v[136:137] offset:256
    v_pk_mul_f32 v[140:141], v[140:141], v[64:65]
    v_pk_mul_f32 v[142:143], v[142:143], v[66:67]
    v_cvt_pk_bf16_f32 v140, v140, v141
    v_cvt_pk_bf16_f32 v141, v142, v143
    ds_write_b64 v17, v[140:141] offset:512
M_st:
    s_lshr_b32 s33, s22, 2
    s_and_b32 s32, s22, 3
    s_mul_i32 s33, s33, 12
    s_add_u32 s32, s32, s33
    s_lshl_b32 s32, s32, 18
    s_lshl_b32 s33, s3, 10
    s_add_u32 s32, s32, s33
    v_add_u32 v12, s32, v16
    s_add_u32 s35, s22, 8
    s_lshr_b32 s33, s35, 2
    s_and_b32 s32, s35, 3
    s_mul_i32 s33, s33, 12
    s_add_u32 s32, s32, s33
    s_lshl_b32 s32, s32, 18
    s_lshl_b32 s33, s3, 10
    s_add_u32 s32, s32, s33
    v_add_u32 v13, s32, v16
    s_mul_i32 s32, s22, 1040
    s_add_u32 s32, s32, 114944
    v_add_u32 v18, s32, v16
    s_waitcnt lgkmcnt(0)
    s_barrier
    ds_read_b128 v[72:75], v18
    s_and_b32 s32, s22, 12
    s_cmp_lg_u32 s32, 4
    s_cbranch_scc1 M_st3
    ds_read_b128 v[76:79], v18 offset:8320
    s_waitcnt lgkmcnt(0)
    buffer_store_dwordx4 v[76:79], v13, s[8:11], 0 offen sc1
M_st3:
    s_waitcnt lgkmcnt(0)
    buffer_store_dwordx4 v[72:75], v12, s[8:11], 0 offen sc1
M_done:
    s_endpgm
.section .rodata,"a"
.p2align 6
.amdhsa_kernel gather_scatter__tensor_product_equiv_equiformer__graph_kernel
  .amdhsa_next_free_vgpr 168
  .amdhsa_next_free_sgpr 70
  .amdhsa_accum_offset 168
  .amdhsa_group_segment_fixed_size 0
  .amdhsa_kernarg_size 96
  .amdhsa_user_sgpr_count 2
  .amdhsa_user_sgpr_kernarg_segment_ptr 1
  .amdhsa_system_sgpr_workgroup_id_x 1
  .amdhsa_float_denorm_mode_32 3
.end_amdhsa_kernel
```
